```python
import torch

def _softmax(x, axis=-1):
    return torch.softmax(x, dim=axis)
def _gelu(x):
    return torch.nn.functional.gelu(x, approximate="tanh")
def _silu(x):
    return torch.nn.functional.silu(x)
def _sigmoid(x):
    return torch.sigmoid(x)
def _layernorm(x, axis=-1, eps=1e-5):
    m = x.mean(dim=axis, keepdim=True)
    v = x.var(dim=axis, keepdim=True, unbiased=False)
    return (x - m) / torch.sqrt(v + eps)
def _scatter_add(tgt, idx, src, axis=0):
    return tgt.clone().index_add_(axis, idx, src)
def _segment_sum(src, seg, n):
    out = torch.zeros((n,) + src.shape[1:], dtype=src.dtype)
    return out.index_add_(0, seg, src)
def _pad(x, pw):
    flat = tuple(v for pair in reversed(pw) for v in pair)
    return torch.nn.functional.pad(x, flat)

kernel_name = 'sequential_preLN__ssm_conv_s4d__glu_gated_glu__prompt'

def setup_inputs():

    _w = (lambda a: (lambda t: t.to(torch.bfloat16) if t.is_floating_point() else t)(torch.as_tensor(a)))
    def _A_setup():
        Bsz, L, D, N = 1, 2048, 512, 128
        return {
            "u": _w((lambda *s: torch.randn(*s, dtype=torch.bfloat16) * 0.05)(Bsz, L, D)),
            "log_A_real": _w((lambda *s: torch.randn(*s, dtype=torch.bfloat16) * 6.4)(D, N) * 0.5),
            "A_imag": _w((lambda *s: torch.randn(*s, dtype=torch.bfloat16) * 0.05)(D, N) * 3.14),
            "C_real": _w((lambda *s: torch.randn(*s, dtype=torch.bfloat16) * 0.05)(D, N) / N ** 0.5),
            "C_imag": _w((lambda *s: torch.randn(*s, dtype=torch.bfloat16) * 0.05)(D, N) / N ** 0.5),
            "log_dt": _w((lambda *s: torch.randn(*s, dtype=torch.bfloat16) * 0.05)(D) * 0.5 - 4.0),
            "D_skip": _w((lambda *s: torch.randn(*s, dtype=torch.bfloat16) * 0.05)(D)),
        }
    _A_in = _A_setup()

    def _B_setup():
        B, S, D, F = 1, 2048, 512, 1376
        return {
            "x": _w((lambda *s: torch.randn(*s, dtype=torch.bfloat16) * 0.05)(B, S, D)),
            "w_gate": _w((lambda *s: torch.randn(*s, dtype=torch.bfloat16) * 0.05)(D, F)),
            "w_up": _w((lambda *s: torch.randn(*s, dtype=torch.bfloat16) * 0.05)(D, F)),
            "w_down": _w((lambda *s: torch.randn(*s, dtype=torch.bfloat16) * 0.05)(F, D)),
        }
    _B_in = _B_setup()

    return {
        "A_u": _A_in["u"],
        "A_log_A_real": _A_in["log_A_real"],
        "A_A_imag": _A_in["A_imag"],
        "A_C_real": _A_in["C_real"],
        "A_C_imag": _A_in["C_imag"],
        "A_log_dt": _A_in["log_dt"],
        "A_D_skip": _A_in["D_skip"],
        "B_x": _B_in["x"],
        "B_w_gate": _B_in["w_gate"],
        "B_w_up": _B_in["w_up"],
        "B_w_down": _B_in["w_down"],
    }

def reference(A_u, A_log_A_real, A_A_imag, A_C_real, A_C_imag, A_log_dt, A_D_skip, B_x, B_w_gate, B_w_up, B_w_down):
    def _A_ref(u, log_A_real, A_imag, C_real, C_imag, log_dt, D_skip):
        L = u.shape[1]
        dt = torch.exp(log_dt)
        A = -torch.exp(log_A_real) + 1j * A_imag
        C = (C_real + 1j * C_imag) * dt[:, None]
        pos = (lambda x, dt: x.to(dt))(torch.arange(L), log_dt.dtype)
        P = torch.exp((A * dt[:, None])[:, :, None] * pos[None, None, :])
        K = 2.0 * torch.einsum("dn,dnl->dl", C, P).real
        L2 = 2 * L
        u_t = (lambda x, *d: x.permute(*d))(u, 0, 2, 1)
        Kf = (lambda x, *a, **k: torch.fft.rfft(x.float(), *a, **k))(K, L2)
        Uf = (lambda x, *a, **k: torch.fft.rfft(x.float(), *a, **k))(u_t, L2)
        y = (lambda x, *a, **k: torch.fft.irfft(x, *a, **k).to(torch.bfloat16))(Uf * Kf[None, :, :], L2)[:, :, :L]
        y = (lambda x, *d: x.permute(*d))(y, 0, 2, 1)
        return y + u * D_skip[None, None, :]

    def _B_ref(x, w_gate, w_up, w_down):
        g = torch.einsum("bsd,df->bsf", x, w_gate)
        u = torch.einsum("bsd,df->bsf", x, w_up)
        h = _sigmoid(g) * u
        return torch.einsum("bsf,fd->bsd", h, w_down)

    x = A_u
    h = x + _A_ref(_layernorm(x, axis=-1), A_log_A_real, A_A_imag, A_C_real, A_C_imag, A_log_dt, A_D_skip)
    h2 = h + _B_ref(_layernorm(h, axis=-1), B_w_gate, B_w_up, B_w_down)
    return h2
```

```asm
; @launch grid=(256,1,1) block=(512,1,1) lds=163840
.amdgcn_target "amdgcn-amd-amdhsa--gfx950"
.text
.globl sequential_preLN__ssm_conv_s4d__glu_gated_glu__prompt_kernel
.p2align 8
.type sequential_preLN__ssm_conv_s4d__glu_gated_glu__prompt_kernel,@function
sequential_preLN__ssm_conv_s4d__glu_gated_glu__prompt_kernel:
    s_cmp_ge_u32 s2, 256
    s_cbranch_scc1 B_exit
    s_load_dwordx16 s[4:19], s[0:1], 0
    s_load_dwordx2 s[30:31], s[0:1], 104
    s_load_dwordx4 s[24:27], s[0:1], 64
    s_load_dwordx2 s[28:29], s[0:1], 80
    s_getpc_b64 s[50:51]
B_pc:
    s_lshr_b32 s52, s2, 3
    s_lshl_b32 s52, s52, 11
    v_and_b32 v44, 15, v0
    v_lshl_add_u32 v44, v44, 7, s52
    v_min_u32 v44, code_end-B_pc-4, v44
    v_cmp_gt_u32 vcc, 16, v0
    s_nop 0
    s_and_saveexec_b64 s[54:55], vcc
    s_cbranch_execz B_nocode
    global_load_dword v48, v44, s[50:51]
B_nocode:
    s_mov_b64 exec, s[54:55]
    s_and_b32 s3, s2, 7
    s_lshl_b32 s3, s3, 5
    s_lshr_b32 s20, s2, 3
    s_add_u32 s3, s3, s20
    s_lshl_b32 s20, s3, 2
    s_lshl_b32 s21, s3, 9
    s_lshl_b32 s56, s2, 13
    v_and_b32 v33, 255, v0
    v_lshl_add_u32 v1, v33, 1, s21
    v_lshrrev_b32 v34, 6, v0
    v_and_b32 v42, 63, v0
    v_readfirstlane_b32 s60, v34
    v_and_b32 v41, 3, v0
    v_and_b32 v2, 0x1fc, v0
    v_lshl_add_u32 v2, v2, 1, s56
    v_lshl_add_u32 v2, v41, 11, v2
    s_waitcnt lgkmcnt(0)
    global_load_dwordx2 v[8:9], v2, s[4:5] offset:0 sc1 nt
    global_load_dwordx2 v[12:13], v2, s[4:5] offset:1024 sc1 nt
    s_load_dwordx2 s[32:33], s[30:31], 20480
    s_add_u32 s36, s30, 0x100000
    s_addc_u32 s37, s31, 0
    s_mov_b32 s38, 0x410000
    s_mov_b32 s39, 0x20000
    s_mov_b32 s40, s30
    s_mov_b32 s41, s31
    s_mov_b32 s42, 0x40000
    s_mov_b32 s43, 0x20000
    s_add_u32 s44, s30, 0xffc00
    s_addc_u32 s45, s31, 0
    s_mov_b32 s46, 0x208400
    s_mov_b32 s47, 0x20000
    s_lshr_b32 s59, s60, 2
    s_bfe_u32 s61, s60, 0x10001
    s_and_b32 s62, s60, 1
    s_and_b32 s19, s60, 3
    v_lshlrev_b32 v34, 3, v33
    v_sub_u32 v34, 2047, v34
    v_cvt_f32_u32 v35, v34
    s_mul_i32 s63, s59, 1568
    v_mov_b32 v36, s63
    s_add_u32 s63, s63, 0x8500
    v_lshl_add_u32 v34, v34, 1, s63
    v_subrev_u32 v37, 2814, v34
    v_cmp_gt_u32 vcc, 16, v33
    s_nop 1
    v_cndmask_b32 v34, v34, v37, vcc
    v_subrev_u32 v37, 16, v33
    v_cmp_gt_u32 vcc, 112, v37
    s_sub_u32 s63, s63, 2
    v_mov_b32 v37, s63
    v_cndmask_b32 v34, v34, v37, vcc
    v_cndmask_b32 v39, 2, 0, vcc
    v_subrev_u32 v37, 128, v33
    v_cmp_le_u32 vcc, 104, v37
    v_subrev_u32 v37, 127, v33
    v_mov_b32 v38, 105
    v_cmp_le_u32 s[54:55], v38, v37
    v_subrev_f32 v37, 0x0, v35
    v_subrev_f32 v38, 0x3f800000, v35
    v_cvt_pk_bf16_f32 v37, v37, v38
    v_mad_u32_u16 v24, v37, 2, v36 op_sel:[0,0,0,0]
    v_cndmask_b32 v24, v24, v34, vcc
    v_sub_u32 v34, v34, v39
    v_mad_u32_u16 v25, v37, 2, v36 op_sel:[1,0,0,0]
    v_cndmask_b32 v25, v25, v34, vcc
    v_sub_u32 v34, v34, v39
    v_subrev_f32 v37, 0x40000000, v35
    v_subrev_f32 v38, 0x40400000, v35
    v_cvt_pk_bf16_f32 v37, v37, v38
    v_mad_u32_u16 v26, v37, 2, v36 op_sel:[0,0,0,0]
    v_cndmask_b32 v26, v26, v34, vcc
    v_sub_u32 v34, v34, v39
    v_mad_u32_u16 v27, v37, 2, v36 op_sel:[1,0,0,0]
    v_cndmask_b32 v27, v27, v34, s[54:55]
    v_sub_u32 v34, v34, v39
    v_subrev_f32 v37, 0x40800000, v35
    v_subrev_f32 v38, 0x40a00000, v35
    v_cvt_pk_bf16_f32 v37, v37, v38
    v_mad_u32_u16 v28, v37, 2, v36 op_sel:[0,0,0,0]
    v_cndmask_b32 v28, v28, v34, s[54:55]
    v_sub_u32 v34, v34, v39
    v_mad_u32_u16 v29, v37, 2, v36 op_sel:[1,0,0,0]
    v_cndmask_b32 v29, v29, v34, s[54:55]
    v_sub_u32 v34, v34, v39
    v_subrev_f32 v37, 0x40c00000, v35
    v_subrev_f32 v38, 0x40e00000, v35
    v_cvt_pk_bf16_f32 v37, v37, v38
    v_mad_u32_u16 v30, v37, 2, v36 op_sel:[0,0,0,0]
    v_cndmask_b32 v30, v30, v34, s[54:55]
    v_sub_u32 v34, v34, v39
    v_mad_u32_u16 v31, v37, 2, v36 op_sel:[1,0,0,0]
    v_cndmask_b32 v31, v31, v34, s[54:55]
    v_sub_u32 v34, v34, v39
    v_subrev_f32 v37, 0x41000000, v35
    v_subrev_f32 v38, 0x41100000, v35
    v_cvt_pk_bf16_f32 v37, v37, v38
    v_mad_u32_u16 v32, v37, 2, v36 op_sel:[0,0,0,0]
    v_cndmask_b32 v32, v32, v34, s[54:55]
    v_mov_b32 v43, s20
    global_load_ushort v4, v1, s[6:7] sc1 nt
    global_load_ushort v5, v1, s[8:9] sc1 nt
    global_load_ushort v6, v1, s[10:11] sc1 nt
    global_load_ushort v7, v1, s[12:13] sc1 nt
    global_load_dword v219, v43, s[16:17]
    global_load_dword v43, v43, s[14:15]
    s_and_b32 s16, s2, 3
    s_lshl_b32 s16, s16, 2
    s_lshr_b32 s17, s2, 6
    s_add_u32 s16, s16, s17
    s_bfe_u32 s5, s2, 0x30003
    s_and_b32 s17, s2, 4
    s_lshl_b32 s17, s17, 1
    s_add_u32 s17, s17, s5
    s_mul_i32 s63, s5, 4
    s_lshr_b32 s63, s63, 3
    s_lshl_b32 s63, s63, 2
    s_add_u32 s63, s63, 3
    s_cmp_eq_u32 s16, s63
    s_cselect_b32 s16, 16, s16
    s_cmp_gt_u32 s16, s63
    s_subb_u32 s16, s16, 0
    s_lshl_b32 s5, s5, 1
    s_cmp_eq_u32 s62, 1
    s_cselect_b32 s48, s26, s24
    s_cselect_b32 s49, s27, s25
    s_cmp_eq_u32 s16, 15
    s_cselect_b32 s50, 0, 1409024
    s_mov_b32 s51, 0x20000
    v_mov_b32 v240, 0
    v_mov_b32 v241, 0
    v_mov_b32 v242, 0
    s_cmp_eq_u32 s59, 1
    s_cbranch_scc0 B_now
    s_mul_i32 s4, s61, 44032
    s_mul_i32 s6, s16, 192
    s_add_u32 s4, s4, s6
    s_mul_i32 s6, s62, 6144
    s_mul_i32 s7, s61, 3072
    s_add_u32 s6, s6, s7
    s_lshl_b32 s7, s62, 1
    s_cmp_eq_u32 s16, 14
    s_cselect_b32 s8, 4, 12
    v_mov_b32 v39, 0x7fffffff
    v_add_u32 v36, 0, v42
    v_mul_u32_u24 v37, 5462, v36
    v_lshrrev_b32 v37, 16, v37
    v_mul_u32_u24 v38, 12, v37
    v_sub_u32 v38, v36, v38
    v_xor_b32 v38, s7, v38
    v_mul_u32_u24 v37, 2752, v37
    v_lshl_add_u32 v37, v38, 4, v37
    v_subrev_u32 v37, 0, v37
    v_add_u32 v240, s4, v37
    v_cmp_le_u32 vcc, s8, v38
    s_nop 1
    v_cndmask_b32 v240, v240, v39, vcc
    v_add_u32 v36, 64, v42
    v_mul_u32_u24 v37, 5462, v36
    v_lshrrev_b32 v37, 16, v37
    v_mul_u32_u24 v38, 12, v37
    v_sub_u32 v38, v36, v38
    v_xor_b32 v38, s7, v38
    v_mul_u32_u24 v37, 2752, v37
    v_lshl_add_u32 v37, v38, 4, v37
    v_subrev_u32 v37, 1024, v37
    v_add_u32 v241, s4, v37
    v_cmp_le_u32 vcc, s8, v38
    s_nop 1
    v_cndmask_b32 v241, v241, v39, vcc
    v_add_u32 v36, 128, v42
    v_mul_u32_u24 v37, 5462, v36
    v_lshrrev_b32 v37, 16, v37
    v_mul_u32_u24 v38, 12, v37
    v_sub_u32 v38, v36, v38
    v_xor_b32 v38, s7, v38
    v_mul_u32_u24 v37, 2752, v37
    v_lshl_add_u32 v37, v38, 4, v37
    v_subrev_u32 v37, 2048, v37
    v_add_u32 v242, s4, v37
    v_cmp_le_u32 vcc, s8, v38
    s_nop 1
    v_cndmask_b32 v242, v242, v39, vcc
B_now:
    v_mov_b32 v34, 0
    v_lshlrev_b32 v35, 2, v33
    s_mul_i32 s63, s59, 4608
    s_add_u32 s63, s63, 87360
    v_add_u32 v36, s63, v35
    v_cmp_gt_u32 vcc, 120, v33
    s_nop 0
    s_and_saveexec_b64 s[54:55], vcc
    ds_write_b32 v36, v34
    s_mov_b64 exec, s[54:55]
    s_mul_i32 s63, s59, 8320
    s_add_u32 s63, s63, 70720
    v_lshl_add_u32 v214, v33, 4, s63
    v_add_u32 v36, s63, v35
    s_mul_i32 s63, s59, 1568
    s_add_u32 s63, s63, 67596
    v_mov_b32 v37, s63
    v_cmp_gt_u32 vcc, 16, v33
    s_nop 0
    s_and_saveexec_b64 s[54:55], vcc
    ds_write_b32 v36, v34 offset:4096
    ds_write_b32 v36, v34 offset:8256
    ds_write_b32 v37, v34
    s_mov_b64 exec, s[54:55]
    v_mov_b32 v250, 98624
    v_mov_b32 v251, 1
    ds_write_b32 v250, v34
    v_and_b32 v216, 15, v0
    v_bfe_u32 v217, v0, 4, 2
    v_and_b32 v38, 1, v217
    v_lshrrev_b32 v39, 1, v217
    v_lshlrev_b32 v20, 8, v38
    v_lshl_add_u32 v20, v39, 7, v20
    v_mul_u32_u24 v21, 528, v216
    v_add_u32 v20, v20, v21
    s_lshr_b32 s57, s60, 1
    s_mul_i32 s63, s62, 8448
    s_add_u32 s63, s63, 50688
    s_mul_i32 s64, s62, 25344
    s_mul_i32 s58, s57, 8448
    s_add_u32 s64, s64, s58
    s_cmp_eq_u32 s57, 2
    s_cselect_b32 s58, s63, s64
    s_cselect_b32 s63, s64, s63
    v_add_u32 v21, s63, v20
    v_add_u32 v20, s58, v20
    v_lshlrev_b32 v22, 7, v39
    v_lshl_add_u32 v22, v38, 2, v22
    v_lshl_add_u32 v22, v216, 3, v22
    v_mov_b32 v23, 2
    s_cmp_eq_u32 s57, 0
    s_cbranch_scc1 B_ka
    v_lshlrev_b32 v22, 4, v216
    v_lshl_add_u32 v22, v217, 2, v22
    v_add_u32 v22, 512, v22
    s_cmp_eq_u32 s57, 2
    s_cbranch_scc1 B_ka
    v_sub_u32 v22, 2, v39
    v_lshlrev_b32 v22, v22, v216
    v_lshl_add_u32 v22, v217, 6, v22
    v_add_u32 v22, 256, v22
    v_mad_u32_u24 v23, v39, 30, 2
B_ka:
    v_add_u32 v23, v22, v23
    s_mul_i32 s63, s62, 1568
    s_add_u32 s63, s63, 67600
    v_lshl_add_u32 v22, v22, 1, s63
    v_lshl_add_u32 v23, v23, 1, s63
    s_mul_i32 s63, s61, 25344
    s_lshl_b32 s64, s62, 8
    s_add_u32 s52, s63, s64
    s_mul_i32 s63, s61, 8448
    s_add_u32 s53, s63, s64
    v_lshlrev_b32 v1, 4, v42
    v_lshl_add_u32 v1, s60, 11, v1
    s_mul_i32 s56, s2, 16640
    v_lshrrev_b32 v2, 2, v0
    v_mul_u32_u24 v2, 16640, v2
    v_lshl_add_u32 v2, v41, 4, v2
    v_lshlrev_b32 v3, 4, v0
    s_and_b32 s18, s3, 0xe0
    s_and_b32 s63, s3, 1
    s_lshl_b32 s63, s63, 4
    s_add_u32 s18, s18, s63
    s_bfe_u32 s63, s3, 0x40001
    s_add_u32 s18, s18, s63
    s_lshl_b32 s18, s18, 6
    s_bfe_u32 s63, s2, 0x30001
    s_lshl_b32 s63, s63, 11
    v_xor_b32 v40, s63, v1
    v_bfe_u32 v34, v0, 3, 3
    v_lshlrev_b32 v34, 11, v34
    v_xor_b32 v34, s18, v34
    v_add_u32 v2, v2, v34
    s_mov_b32 s22, s18
    s_mov_b32 s18, 0
    s_add_u32 s21, s18, 2129920
    s_mov_b32 s20, 8192
    v_lshlrev_b32 v213, 3, v0
    v_lshlrev_b32 v218, 2, v0
    v_add_u32 v215, 87840, v218
    v_add_u32 v218, 96576, v218
    s_mov_b32 s65, 0x3f803f80
    s_cmp_eq_u32 s59, 1
    s_cbranch_scc1 B_cs
    v_sub_u32 v208, 1807, v216
    v_lshrrev_b32 v208, 1, v208
    v_lshl_add_u32 v208, v217, 2, v208
    v_lshlrev_b32 v208, 2, v208
    v_and_b32 v209, 1, v216
    v_xor_b32 v209, 1, v209
    v_mul_u32_u24 v209, 4160, v209
    s_mul_i32 s63, s61, 8320
    s_add_u32 s63, s63, s64
    s_add_u32 s63, s63, 70208
    v_add3_u32 v208, v208, v209, s63
    v_subrev_u32 v209, 1024, v208
    v_subrev_u32 v210, 2048, v208
    v_lshlrev_b32 v211, 4, v217
    v_lshlrev_b32 v223, 2, v216
    v_sub_u32 v211, v211, v223
    s_mul_i32 s54, s61, 8320
    s_add_u32 s54, s54, 70780
    v_add_u32 v211, s54, v211
    v_lshlrev_b32 v212, 5, v216
    v_lshl_add_u32 v212, v217, 4, v212
    s_mul_i32 s63, s61, 4608
    s_add_u32 s63, s63, s64
    s_add_u32 s63, s63, 87360
    v_add_u32 v212, s63, v212
    s_mul_i32 s54, s62, 768
    v_add_u32 v222, s54, v212
B_cs:
    s_waitcnt lgkmcnt(0)
    s_add_u32 s32, s32, 1
    v_mov_b64 v[220:221], s[32:33]
    v_mov_b64 v[10:11], s[32:33]
    v_mov_b64 v[14:15], s[32:33]
    s_cmp_eq_u32 s59, 1
    s_cbranch_scc1 B_rw1
    s_waitcnt vmcnt(6)
B_rw1:
    s_waitcnt vmcnt(6)
    v_swap_b32 v9, v12
    buffer_store_dwordx4 v[8:11], v40, s[36:39], s56 offen offset:0 sc1
    buffer_store_dwordx4 v[12:15], v40, s[36:39], s56 offen offset:1024 sc1
    v_dot2_f32_bf16 v16, v8, s65, 0
    v_dot2_f32_bf16 v18, v8, v8, 0
    v_dot2_f32_bf16 v17, v9, s65, 0
    v_dot2_f32_bf16 v19, v9, v9, 0
    v_dot2_f32_bf16 v16, v12, s65, v16
    v_dot2_f32_bf16 v18, v12, v12, v18
    v_dot2_f32_bf16 v17, v13, s65, v17
    v_dot2_f32_bf16 v19, v13, v13, v19
    s_nop 0
    v_permlane32_swap_b32 v16, v18
    s_nop 0
    v_permlane32_swap_b32 v17, v19
    v_add_f32 v16, v16, v18
    v_add_f32 v17, v17, v19
    s_nop 1
    v_permlane16_swap_b32 v16, v17
    v_add_f32 v16, v16, v17
    s_nop 1
    v_add_f32_dpp v16, v16, v16 row_ror:8 row_mask:0xf bank_mask:0xf
    s_nop 1
    v_add_f32_dpp v16, v16, v16 row_ror:4 row_mask:0xf bank_mask:0xf
    ds_write_b32 v218, v16
    s_add_u32 s32, s30, 0x510000
    s_addc_u32 s33, s31, 0
    s_mov_b32 s34, 0x560000
    s_mov_b32 s35, 0x20000
    v_mov_b32 v248, 0
    v_mov_b32 v249, 0
    v_mov_b32 v252, 0
    v_mov_b32 v223, 0
    s_cmp_eq_u32 s59, 1
    s_cbranch_scc1 B_noband
    v_lshlrev_b32 v34, 3, v217
    v_mov_b32 v38, 0x10001
    v_mov_b32 v35, 8176
    v_lshlrev_b32 v35, v216, v35
    v_lshrrev_b32 v35, v34, v35
    v_bfe_u32 v36, v35, 0, 2
    v_lshl_or_b32 v36, v36, 15, v36
    v_and_b32 v36, v38, v36
    v_mul_u32_u24 v192, 0x3f80, v36
    v_bfe_u32 v36, v35, 2, 2
    v_lshl_or_b32 v36, v36, 15, v36
    v_and_b32 v36, v38, v36
    v_mul_u32_u24 v193, 0x3f80, v36
    v_bfe_u32 v36, v35, 4, 2
    v_lshl_or_b32 v36, v36, 15, v36
    v_and_b32 v36, v38, v36
    v_mul_u32_u24 v194, 0x3f80, v36
    v_bfe_u32 v36, v35, 6, 2
    v_lshl_or_b32 v36, v36, 15, v36
    v_and_b32 v36, v38, v36
    v_mul_u32_u24 v195, 0x3f80, v36
    v_mov_b32 v35, 4064
    v_lshlrev_b32 v35, v216, v35
    v_lshrrev_b32 v35, v34, v35
    v_bfe_u32 v36, v35, 0, 2
    v_lshl_or_b32 v36, v36, 15, v36
    v_and_b32 v36, v38, v36
    v_mul_u32_u24 v204, 0x3f80, v36
    v_bfe_u32 v36, v35, 2, 2
    v_lshl_or_b32 v36, v36, 15, v36
    v_and_b32 v36, v38, v36
    v_mul_u32_u24 v205, 0x3f80, v36
    v_bfe_u32 v36, v35, 4, 2
    v_lshl_or_b32 v36, v36, 15, v36
    v_and_b32 v36, v38, v36
    v_mul_u32_u24 v206, 0x3f80, v36
    v_bfe_u32 v36, v35, 6, 2
    v_lshl_or_b32 v36, v36, 15, v36
    v_and_b32 v36, v38, v36
    v_mul_u32_u24 v207, 0x3f80, v36
    v_mov_b64 v[244:245], -1
    v_mov_b64 v[246:247], -1
    s_lshl_b32 s65, s17, 1
    s_add_u32 s65, s65, s61
    s_mul_i32 s65, s65, 172
    s_lshl_b32 s64, s16, 1
    s_add_u32 s64, s64, s62
    s_add_u32 s65, s65, s64
    s_cmp_le_u32 s64, 13
    s_cselect_b32 s54, 29, 58
    s_add_u32 s54, s54, s65
    s_lshl_b32 s54, s54, 10
    s_cmp_ge_u32 s64, 28
    s_cselect_b32 s54, 0x7ff00000, s54
    v_lshl_add_u32 v249, v42, 4, s54
    v_add_u32 v248, 88064, v249
B_noband:
    s_waitcnt lgkmcnt(0)
    s_barrier
    s_cmp_lg_u32 s60, 0
    s_cbranch_scc1 B_nofin
    v_lshlrev_b32 v34, 2, v42
    v_add_u32 v34, 96576, v34
    ds_read2st64_b32 v[44:45], v34 offset0:0 offset1:1
    ds_read2st64_b32 v[46:47], v34 offset0:2 offset1:3
    ds_read2st64_b32 v[48:49], v34 offset0:4 offset1:5
    ds_read2st64_b32 v[50:51], v34 offset0:6 offset1:7
    v_lshlrev_b32 v35, 4, v42
    s_lshl_b32 s63, s2, 6
    v_mov_b64 v[18:19], v[220:221]
    s_waitcnt lgkmcnt(0)
    v_pk_add_f32 v[44:45], v[44:45], v[46:47]
    v_pk_add_f32 v[48:49], v[48:49], v[50:51]
    v_pk_add_f32 v[44:45], v[44:45], v[48:49]
    v_add_f32 v16, v44, v45
    v_mul_f32 v16, 0x3b000000, v16
    v_mov_b32 v17, v16
    s_nop 1
    v_permlane32_swap_b32 v16, v17
    v_fma_f32 v17, -v16, v16, v17
    v_max_f32 v17, 0, v17
    v_cvt_pk_bf16_f32 v17, v17, v17
    v_and_b32 v17, 0xffff0000, v17
    v_add_f32 v17, 0x3727c5ac, v17
    v_cvt_pk_bf16_f32 v17, v17, v17
    v_and_b32 v17, 0xffff0000, v17
    v_sqrt_f32 v17, v17
    s_nop 0
    v_cvt_pk_bf16_f32 v16, -v16, v17
    v_mov_b32 v17, v16
    s_nop 1
    v_permlane16_swap_b32 v16, v17
    s_mov_b64 exec, 15
    buffer_store_dwordx4 v[16:19], v35, s[40:43], s63 offen sc1
    s_mov_b64 exec, 0xffffff
    v_mov_b32 v52, -1
    v_mov_b32 v53, -1
    v_mov_b32 v54, -1
    v_mov_b32 v55, -1
    s_mul_i32 s63, s2, 384
    s_add_u32 s63, s63, 131072
    buffer_store_dwordx4 v[52:55], v35, s[40:43], s63 offen sc1
    s_mov_b64 exec, -1
    s_waitcnt vmcnt(4)
    s_branch B_fin
B_nofin:
    s_cmp_eq_u32 s59, 1
    s_cbranch_scc1 B_rw2
    s_waitcnt vmcnt(2)
B_rw2:
    s_waitcnt vmcnt(2)
B_fin:
    s_lshl_b32 s63, s61, 4
    v_readfirstlane_b32 s23, v219
    v_lshrrev_b32 v44, s63, v43
    v_lshlrev_b32 v44, 16, v44
    v_mul_f32 v44, 0x3fb8aa3b, v44
    v_exp_f32 v44, v44
    v_lshlrev_b32 v4, 16, v4
    v_lshlrev_b32 v5, 16, v5
    v_mul_f32 v4, 0x3fb8aa3b, v4
    v_exp_f32 v4, v4
    v_cvt_pk_bf16_f32 v44, v44, v44
    v_and_b32 v44, 0xffff0000, v44
    v_mul_f32 v45, 0x3e22f983, v44
    v_cvt_pk_bf16_f32 v4, v4, v4
    v_and_b32 v4, 0xffff0000, v4
    v_mul_f32 v5, v5, v45
    v_mul_f32 v4, v4, v44
    v_mul_f32 v4, 0xbfb8aa3b, v4
    s_mov_b32 m0, s52
    s_cmp_eq_u32 s59, 1
    s_cbranch_scc1 B_r1
    v_mul_f32 v88, 0x3f800000, v4
    v_mul_f32 v89, 0x3f800000, v5
    v_mul_f32 v90, 0x43000000, v4
    v_mul_f32 v91, 0x43000000, v5
    v_fract_f32 v89, v89
    v_exp_f32 v88, v88
    v_fract_f32 v91, v91
    v_exp_f32 v90, v90
    v_cos_f32 v66, v89
    v_sin_f32 v67, v89
    v_cos_f32 v52, v91
    v_sin_f32 v53, v91
    v_pk_mul_f32 v[66:67], v[66:67], v[88:89] op_sel_hi:[1,0]
    v_pk_mul_f32 v[52:53], v[52:53], v[90:91] op_sel_hi:[1,0]
    v_mov_b32 v84, 0x3f80
    ds_write_addtid_b32 v84
    v_cvt_pk_bf16_f32 v85, v66, v67
    ds_write_addtid_b32 v85 offset:528
    v_cvt_pk_bf16_f32 v86, v52, v53
    ds_write_addtid_b32 v86 offset:4224
    v_pk_mul_f32 v[56:57], v[52:53], v[66:67] op_sel:[0,0] op_sel_hi:[0,1]
    v_pk_fma_f32 v[82:83], v[52:53], v[66:67], v[56:57] op_sel:[1,1,0] op_sel_hi:[1,0,1] neg_lo:[1,0,0]
    v_cvt_pk_bf16_f32 v87, v82, v83
    ds_write_addtid_b32 v87 offset:4752
    v_pk_mul_f32 v[54:55], v[66:67], v[66:67] op_sel:[0,0] op_sel_hi:[0,1]
    v_pk_fma_f32 v[68:69], v[66:67], v[66:67], v[54:55] op_sel:[1,1,0] op_sel_hi:[1,0,1] neg_lo:[1,0,0]
    v_cvt_pk_bf16_f32 v84, v68, v69
    ds_write_addtid_b32 v84 offset:1056
    v_pk_mul_f32 v[56:57], v[52:53], v[68:69] op_sel:[0,0] op_sel_hi:[0,1]
    v_pk_fma_f32 v[82:83], v[52:53], v[68:69], v[56:57] op_sel:[1,1,0] op_sel_hi:[1,0,1] neg_lo:[1,0,0]
    v_cvt_pk_bf16_f32 v85, v82, v83
    ds_write_addtid_b32 v85 offset:5280
    v_pk_mul_f32 v[54:55], v[68:69], v[66:67] op_sel:[0,0] op_sel_hi:[0,1]
    v_pk_fma_f32 v[70:71], v[68:69], v[66:67], v[54:55] op_sel:[1,1,0] op_sel_hi:[1,0,1] neg_lo:[1,0,0]
    v_cvt_pk_bf16_f32 v86, v70, v71
    ds_write_addtid_b32 v86 offset:1584
    v_pk_mul_f32 v[56:57], v[52:53], v[70:71] op_sel:[0,0] op_sel_hi:[0,1]
    v_pk_fma_f32 v[82:83], v[52:53], v[70:71], v[56:57] op_sel:[1,1,0] op_sel_hi:[1,0,1] neg_lo:[1,0,0]
    v_cvt_pk_bf16_f32 v87, v82, v83
    ds_write_addtid_b32 v87 offset:5808
    v_pk_mul_f32 v[54:55], v[70:71], v[66:67] op_sel:[0,0] op_sel_hi:[0,1]
    v_pk_fma_f32 v[72:73], v[70:71], v[66:67], v[54:55] op_sel:[1,1,0] op_sel_hi:[1,0,1] neg_lo:[1,0,0]
    v_cvt_pk_bf16_f32 v84, v72, v73
    ds_write_addtid_b32 v84 offset:2112
    v_pk_mul_f32 v[56:57], v[52:53], v[72:73] op_sel:[0,0] op_sel_hi:[0,1]
    v_pk_fma_f32 v[82:83], v[52:53], v[72:73], v[56:57] op_sel:[1,1,0] op_sel_hi:[1,0,1] neg_lo:[1,0,0]
    v_cvt_pk_bf16_f32 v85, v82, v83
    ds_write_addtid_b32 v85 offset:6336
    v_pk_mul_f32 v[54:55], v[72:73], v[66:67] op_sel:[0,0] op_sel_hi:[0,1]
    v_pk_fma_f32 v[74:75], v[72:73], v[66:67], v[54:55] op_sel:[1,1,0] op_sel_hi:[1,0,1] neg_lo:[1,0,0]
    v_cvt_pk_bf16_f32 v86, v74, v75
    ds_write_addtid_b32 v86 offset:2640
    v_pk_mul_f32 v[56:57], v[52:53], v[74:75] op_sel:[0,0] op_sel_hi:[0,1]
    v_pk_fma_f32 v[82:83], v[52:53], v[74:75], v[56:57] op_sel:[1,1,0] op_sel_hi:[1,0,1] neg_lo:[1,0,0]
    v_cvt_pk_bf16_f32 v87, v82, v83
    ds_write_addtid_b32 v87 offset:6864
    v_pk_mul_f32 v[54:55], v[74:75], v[66:67] op_sel:[0,0] op_sel_hi:[0,1]
    v_pk_fma_f32 v[76:77], v[74:75], v[66:67], v[54:55] op_sel:[1,1,0] op_sel_hi:[1,0,1] neg_lo:[1,0,0]
    v_cvt_pk_bf16_f32 v84, v76, v77
    ds_write_addtid_b32 v84 offset:3168
    v_pk_mul_f32 v[56:57], v[52:53], v[76:77] op_sel:[0,0] op_sel_hi:[0,1]
    v_pk_fma_f32 v[82:83], v[52:53], v[76:77], v[56:57] op_sel:[1,1,0] op_sel_hi:[1,0,1] neg_lo:[1,0,0]
    v_cvt_pk_bf16_f32 v85, v82, v83
    ds_write_addtid_b32 v85 offset:7392
    v_pk_mul_f32 v[54:55], v[76:77], v[66:67] op_sel:[0,0] op_sel_hi:[0,1]
    v_pk_fma_f32 v[78:79], v[76:77], v[66:67], v[54:55] op_sel:[1,1,0] op_sel_hi:[1,0,1] neg_lo:[1,0,0]
    v_cvt_pk_bf16_f32 v86, v78, v79
    ds_write_addtid_b32 v86 offset:3696
    v_pk_mul_f32 v[56:57], v[52:53], v[78:79] op_sel:[0,0] op_sel_hi:[0,1]
    v_pk_fma_f32 v[82:83], v[52:53], v[78:79], v[56:57] op_sel:[1,1,0] op_sel_hi:[1,0,1] neg_lo:[1,0,0]
    v_cvt_pk_bf16_f32 v87, v82, v83
    ds_write_addtid_b32 v87 offset:7920
    v_pk_mul_f32 v[54:55], v[52:53], v[52:53] op_sel:[0,0] op_sel_hi:[0,1]
    v_pk_fma_f32 v[80:81], v[52:53], v[52:53], v[54:55] op_sel:[1,1,0] op_sel_hi:[1,0,1] neg_lo:[1,0,0]
    v_cvt_pk_bf16_f32 v84, v80, v81
    ds_write_addtid_b32 v84 offset:8448
    v_pk_mul_f32 v[56:57], v[80:81], v[68:69] op_sel:[0,0] op_sel_hi:[0,1]
    v_pk_fma_f32 v[82:83], v[80:81], v[68:69], v[56:57] op_sel:[1,1,0] op_sel_hi:[1,0,1] neg_lo:[1,0,0]
    v_cvt_pk_bf16_f32 v85, v82, v83
    ds_write_addtid_b32 v85 offset:8976
    v_pk_mul_f32 v[56:57], v[80:81], v[72:73] op_sel:[0,0] op_sel_hi:[0,1]
    v_pk_fma_f32 v[82:83], v[80:81], v[72:73], v[56:57] op_sel:[1,1,0] op_sel_hi:[1,0,1] neg_lo:[1,0,0]
    v_cvt_pk_bf16_f32 v86, v82, v83
    ds_write_addtid_b32 v86 offset:9504
    v_pk_mul_f32 v[56:57], v[80:81], v[76:77] op_sel:[0,0] op_sel_hi:[0,1]
    v_pk_fma_f32 v[82:83], v[80:81], v[76:77], v[56:57] op_sel:[1,1,0] op_sel_hi:[1,0,1] neg_lo:[1,0,0]
    v_cvt_pk_bf16_f32 v87, v82, v83
    ds_write_addtid_b32 v87 offset:10032
    v_pk_mul_f32 v[54:55], v[80:81], v[52:53] op_sel:[0,0] op_sel_hi:[0,1]
    v_pk_fma_f32 v[80:81], v[80:81], v[52:53], v[54:55] op_sel:[1,1,0] op_sel_hi:[1,0,1] neg_lo:[1,0,0]
    v_cvt_pk_bf16_f32 v84, v80, v81
    ds_write_addtid_b32 v84 offset:10560
    v_pk_mul_f32 v[56:57], v[80:81], v[68:69] op_sel:[0,0] op_sel_hi:[0,1]
    v_pk_fma_f32 v[82:83], v[80:81], v[68:69], v[56:57] op_sel:[1,1,0] op_sel_hi:[1,0,1] neg_lo:[1,0,0]
    v_cvt_pk_bf16_f32 v85, v82, v83
    ds_write_addtid_b32 v85 offset:11088
    v_pk_mul_f32 v[56:57], v[80:81], v[72:73] op_sel:[0,0] op_sel_hi:[0,1]
    v_pk_fma_f32 v[82:83], v[80:81], v[72:73], v[56:57] op_sel:[1,1,0] op_sel_hi:[1,0,1] neg_lo:[1,0,0]
    v_cvt_pk_bf16_f32 v86, v82, v83
    ds_write_addtid_b32 v86 offset:11616
    v_pk_mul_f32 v[56:57], v[80:81], v[76:77] op_sel:[0,0] op_sel_hi:[0,1]
    v_pk_fma_f32 v[82:83], v[80:81], v[76:77], v[56:57] op_sel:[1,1,0] op_sel_hi:[1,0,1] neg_lo:[1,0,0]
    v_cvt_pk_bf16_f32 v87, v82, v83
    ds_write_addtid_b32 v87 offset:12144
    v_pk_mul_f32 v[54:55], v[80:81], v[52:53] op_sel:[0,0] op_sel_hi:[0,1]
    v_pk_fma_f32 v[80:81], v[80:81], v[52:53], v[54:55] op_sel:[1,1,0] op_sel_hi:[1,0,1] neg_lo:[1,0,0]
    v_cvt_pk_bf16_f32 v84, v80, v81
    ds_write_addtid_b32 v84 offset:12672
    v_pk_mul_f32 v[56:57], v[80:81], v[72:73] op_sel:[0,0] op_sel_hi:[0,1]
    v_pk_fma_f32 v[82:83], v[80:81], v[72:73], v[56:57] op_sel:[1,1,0] op_sel_hi:[1,0,1] neg_lo:[1,0,0]
    v_cvt_pk_bf16_f32 v85, v82, v83
    ds_write_addtid_b32 v85 offset:13200
    v_pk_mul_f32 v[54:55], v[80:81], v[52:53] op_sel:[0,0] op_sel_hi:[0,1]
    v_pk_fma_f32 v[80:81], v[80:81], v[52:53], v[54:55] op_sel:[1,1,0] op_sel_hi:[1,0,1] neg_lo:[1,0,0]
    v_cvt_pk_bf16_f32 v86, v80, v81
    ds_write_addtid_b32 v86 offset:13728
    v_pk_mul_f32 v[56:57], v[80:81], v[72:73] op_sel:[0,0] op_sel_hi:[0,1]
    v_pk_fma_f32 v[82:83], v[80:81], v[72:73], v[56:57] op_sel:[1,1,0] op_sel_hi:[1,0,1] neg_lo:[1,0,0]
    v_cvt_pk_bf16_f32 v87, v82, v83
    ds_write_addtid_b32 v87 offset:14256
    v_pk_mul_f32 v[54:55], v[80:81], v[52:53] op_sel:[0,0] op_sel_hi:[0,1]
    v_pk_fma_f32 v[80:81], v[80:81], v[52:53], v[54:55] op_sel:[1,1,0] op_sel_hi:[1,0,1] neg_lo:[1,0,0]
    v_cvt_pk_bf16_f32 v84, v80, v81
    ds_write_addtid_b32 v84 offset:14784
    v_pk_mul_f32 v[56:57], v[80:81], v[72:73] op_sel:[0,0] op_sel_hi:[0,1]
    v_pk_fma_f32 v[82:83], v[80:81], v[72:73], v[56:57] op_sel:[1,1,0] op_sel_hi:[1,0,1] neg_lo:[1,0,0]
    v_cvt_pk_bf16_f32 v85, v82, v83
    ds_write_addtid_b32 v85 offset:15312
    v_pk_mul_f32 v[54:55], v[80:81], v[52:53] op_sel:[0,0] op_sel_hi:[0,1]
    v_pk_fma_f32 v[80:81], v[80:81], v[52:53], v[54:55] op_sel:[1,1,0] op_sel_hi:[1,0,1] neg_lo:[1,0,0]
    v_cvt_pk_bf16_f32 v86, v80, v81
    ds_write_addtid_b32 v86 offset:15840
    v_pk_mul_f32 v[56:57], v[80:81], v[72:73] op_sel:[0,0] op_sel_hi:[0,1]
    v_pk_fma_f32 v[82:83], v[80:81], v[72:73], v[56:57] op_sel:[1,1,0] op_sel_hi:[1,0,1] neg_lo:[1,0,0]
    v_cvt_pk_bf16_f32 v87, v82, v83
    ds_write_addtid_b32 v87 offset:16368
    s_branch B_tab
B_r1:
    v_mul_f32 v88, 0x41000000, v4
    v_mul_f32 v89, 0x41000000, v5
    v_mul_f32 v90, 0x43000000, v4
    v_mul_f32 v91, 0x43000000, v5
    v_mul_f32 v92, 0x44800000, v4
    v_mul_f32 v93, 0x44800000, v5
    v_fract_f32 v89, v89
    v_exp_f32 v88, v88
    v_fract_f32 v91, v91
    v_exp_f32 v90, v90
    v_fract_f32 v93, v93
    v_exp_f32 v92, v92
    v_cos_f32 v50, v89
    v_sin_f32 v51, v89
    v_cos_f32 v52, v91
    v_sin_f32 v53, v91
    v_cos_f32 v80, v93
    v_sin_f32 v81, v93
    v_pk_mul_f32 v[50:51], v[50:51], v[88:89] op_sel_hi:[1,0] neg_hi:[1,0]
    v_pk_mul_f32 v[52:53], v[52:53], v[90:91] op_sel_hi:[1,0]
    v_pk_mul_f32 v[80:81], v[80:81], v[92:93] op_sel_hi:[1,0]
    v_add_f32 v44, v44, v44
    v_lshlrev_b32 v6, 16, v6
    v_lshlrev_b32 v7, 16, v7
    v_pk_mul_f32 v[46:47], v[6:7], v[44:45] op_sel_hi:[1,0] neg_hi:[1,0]
    v_cvt_pk_bf16_f32 v84, v80, v81
    ds_write_addtid_b32 v84 offset:16896
    v_pk_mul_f32 v[54:55], v[80:81], v[52:53] op_sel:[0,0] op_sel_hi:[0,1]
    v_pk_fma_f32 v[80:81], v[80:81], v[52:53], v[54:55] op_sel:[1,1,0] op_sel_hi:[1,0,1] neg_lo:[1,0,0]
    v_cvt_pk_bf16_f32 v85, v80, v81
    ds_write_addtid_b32 v85 offset:17424
    v_pk_mul_f32 v[54:55], v[80:81], v[52:53] op_sel:[0,0] op_sel_hi:[0,1]
    v_pk_fma_f32 v[80:81], v[80:81], v[52:53], v[54:55] op_sel:[1,1,0] op_sel_hi:[1,0,1] neg_lo:[1,0,0]
    v_cvt_pk_bf16_f32 v86, v80, v81
    ds_write_addtid_b32 v86 offset:17952
    v_pk_mul_f32 v[54:55], v[80:81], v[52:53] op_sel:[0,0] op_sel_hi:[0,1]
    v_pk_fma_f32 v[80:81], v[80:81], v[52:53], v[54:55] op_sel:[1,1,0] op_sel_hi:[1,0,1] neg_lo:[1,0,0]
    v_cvt_pk_bf16_f32 v87, v80, v81
    ds_write_addtid_b32 v87 offset:18480
    v_pk_mul_f32 v[54:55], v[80:81], v[52:53] op_sel:[0,0] op_sel_hi:[0,1]
    v_pk_fma_f32 v[80:81], v[80:81], v[52:53], v[54:55] op_sel:[1,1,0] op_sel_hi:[1,0,1] neg_lo:[1,0,0]
    v_cvt_pk_bf16_f32 v84, v80, v81
    ds_write_addtid_b32 v84 offset:19008
    v_pk_mul_f32 v[54:55], v[80:81], v[52:53] op_sel:[0,0] op_sel_hi:[0,1]
    v_pk_fma_f32 v[80:81], v[80:81], v[52:53], v[54:55] op_sel:[1,1,0] op_sel_hi:[1,0,1] neg_lo:[1,0,0]
    v_cvt_pk_bf16_f32 v85, v80, v81
    ds_write_addtid_b32 v85 offset:19536
    v_pk_mul_f32 v[54:55], v[80:81], v[52:53] op_sel:[0,0] op_sel_hi:[0,1]
    v_pk_fma_f32 v[80:81], v[80:81], v[52:53], v[54:55] op_sel:[1,1,0] op_sel_hi:[1,0,1] neg_lo:[1,0,0]
    v_cvt_pk_bf16_f32 v86, v80, v81
    ds_write_addtid_b32 v86 offset:20064
    v_pk_mul_f32 v[54:55], v[80:81], v[52:53] op_sel:[0,0] op_sel_hi:[0,1]
    v_pk_fma_f32 v[80:81], v[80:81], v[52:53], v[54:55] op_sel:[1,1,0] op_sel_hi:[1,0,1] neg_lo:[1,0,0]
    v_cvt_pk_bf16_f32 v87, v80, v81
    ds_write_addtid_b32 v87 offset:20592
    v_pk_mul_f32 v[54:55], v[80:81], v[52:53] op_sel:[0,0] op_sel_hi:[0,1]
    v_pk_fma_f32 v[80:81], v[80:81], v[52:53], v[54:55] op_sel:[1,1,0] op_sel_hi:[1,0,1] neg_lo:[1,0,0]
    v_cvt_pk_bf16_f32 v84, v80, v81
    ds_write_addtid_b32 v84 offset:21120
    s_mov_b32 m0, s53
    v_cvt_pk_bf16_f32 v85, v46, v47
    ds_write_addtid_b32 v85 offset:50688
    v_pk_mul_f32 v[56:57], v[46:47], v[50:51] op_sel:[0,0] op_sel_hi:[0,1]
    v_pk_fma_f32 v[46:47], v[46:47], v[50:51], v[56:57] op_sel:[1,1,0] op_sel_hi:[1,0,1] neg_lo:[1,0,0]
    v_cvt_pk_bf16_f32 v86, v46, v47
    ds_write_addtid_b32 v86 offset:51216
    v_pk_mul_f32 v[56:57], v[46:47], v[50:51] op_sel:[0,0] op_sel_hi:[0,1]
    v_pk_fma_f32 v[46:47], v[46:47], v[50:51], v[56:57] op_sel:[1,1,0] op_sel_hi:[1,0,1] neg_lo:[1,0,0]
    v_cvt_pk_bf16_f32 v87, v46, v47
    ds_write_addtid_b32 v87 offset:51744
    v_pk_mul_f32 v[56:57], v[46:47], v[50:51] op_sel:[0,0] op_sel_hi:[0,1]
    v_pk_fma_f32 v[46:47], v[46:47], v[50:51], v[56:57] op_sel:[1,1,0] op_sel_hi:[1,0,1] neg_lo:[1,0,0]
    v_cvt_pk_bf16_f32 v84, v46, v47
    ds_write_addtid_b32 v84 offset:52272
    v_pk_mul_f32 v[56:57], v[46:47], v[50:51] op_sel:[0,0] op_sel_hi:[0,1]
    v_pk_fma_f32 v[46:47], v[46:47], v[50:51], v[56:57] op_sel:[1,1,0] op_sel_hi:[1,0,1] neg_lo:[1,0,0]
    v_cvt_pk_bf16_f32 v85, v46, v47
    ds_write_addtid_b32 v85 offset:52800
    v_pk_mul_f32 v[56:57], v[46:47], v[50:51] op_sel:[0,0] op_sel_hi:[0,1]
    v_pk_fma_f32 v[46:47], v[46:47], v[50:51], v[56:57] op_sel:[1,1,0] op_sel_hi:[1,0,1] neg_lo:[1,0,0]
    v_cvt_pk_bf16_f32 v86, v46, v47
    ds_write_addtid_b32 v86 offset:53328
    v_pk_mul_f32 v[56:57], v[46:47], v[50:51] op_sel:[0,0] op_sel_hi:[0,1]
    v_pk_fma_f32 v[46:47], v[46:47], v[50:51], v[56:57] op_sel:[1,1,0] op_sel_hi:[1,0,1] neg_lo:[1,0,0]
    v_cvt_pk_bf16_f32 v87, v46, v47
    ds_write_addtid_b32 v87 offset:53856
    v_pk_mul_f32 v[56:57], v[46:47], v[50:51] op_sel:[0,0] op_sel_hi:[0,1]
    v_pk_fma_f32 v[46:47], v[46:47], v[50:51], v[56:57] op_sel:[1,1,0] op_sel_hi:[1,0,1] neg_lo:[1,0,0]
    v_cvt_pk_bf16_f32 v84, v46, v47
    ds_write_addtid_b32 v84 offset:54384
    v_pk_mul_f32 v[56:57], v[46:47], v[50:51] op_sel:[0,0] op_sel_hi:[0,1]
    v_pk_fma_f32 v[46:47], v[46:47], v[50:51], v[56:57] op_sel:[1,1,0] op_sel_hi:[1,0,1] neg_lo:[1,0,0]
    v_cvt_pk_bf16_f32 v85, v46, v47
    ds_write_addtid_b32 v85 offset:54912
    v_pk_mul_f32 v[56:57], v[46:47], v[50:51] op_sel:[0,0] op_sel_hi:[0,1]
    v_pk_fma_f32 v[46:47], v[46:47], v[50:51], v[56:57] op_sel:[1,1,0] op_sel_hi:[1,0,1] neg_lo:[1,0,0]
    v_cvt_pk_bf16_f32 v86, v46, v47
    ds_write_addtid_b32 v86 offset:55440
    v_pk_mul_f32 v[56:57], v[46:47], v[50:51] op_sel:[0,0] op_sel_hi:[0,1]
    v_pk_fma_f32 v[46:47], v[46:47], v[50:51], v[56:57] op_sel:[1,1,0] op_sel_hi:[1,0,1] neg_lo:[1,0,0]
    v_cvt_pk_bf16_f32 v87, v46, v47
    ds_write_addtid_b32 v87 offset:55968
    v_pk_mul_f32 v[56:57], v[46:47], v[50:51] op_sel:[0,0] op_sel_hi:[0,1]
    v_pk_fma_f32 v[46:47], v[46:47], v[50:51], v[56:57] op_sel:[1,1,0] op_sel_hi:[1,0,1] neg_lo:[1,0,0]
    v_cvt_pk_bf16_f32 v84, v46, v47
    ds_write_addtid_b32 v84 offset:56496
    v_pk_mul_f32 v[56:57], v[46:47], v[50:51] op_sel:[0,0] op_sel_hi:[0,1]
    v_pk_fma_f32 v[46:47], v[46:47], v[50:51], v[56:57] op_sel:[1,1,0] op_sel_hi:[1,0,1] neg_lo:[1,0,0]
    v_cvt_pk_bf16_f32 v85, v46, v47
    ds_write_addtid_b32 v85 offset:57024
    v_pk_mul_f32 v[56:57], v[46:47], v[50:51] op_sel:[0,0] op_sel_hi:[0,1]
    v_pk_fma_f32 v[46:47], v[46:47], v[50:51], v[56:57] op_sel:[1,1,0] op_sel_hi:[1,0,1] neg_lo:[1,0,0]
    v_cvt_pk_bf16_f32 v86, v46, v47
    ds_write_addtid_b32 v86 offset:57552
    v_pk_mul_f32 v[56:57], v[46:47], v[50:51] op_sel:[0,0] op_sel_hi:[0,1]
    v_pk_fma_f32 v[46:47], v[46:47], v[50:51], v[56:57] op_sel:[1,1,0] op_sel_hi:[1,0,1] neg_lo:[1,0,0]
    v_cvt_pk_bf16_f32 v87, v46, v47
    ds_write_addtid_b32 v87 offset:58080
    v_pk_mul_f32 v[56:57], v[46:47], v[50:51] op_sel:[0,0] op_sel_hi:[0,1]
    v_pk_fma_f32 v[46:47], v[46:47], v[50:51], v[56:57] op_sel:[1,1,0] op_sel_hi:[1,0,1] neg_lo:[1,0,0]
    v_cvt_pk_bf16_f32 v84, v46, v47
    ds_write_addtid_b32 v84 offset:58608
B_tab:
    s_waitcnt lgkmcnt(0)
    s_barrier
    buffer_load_dwordx4 v[224:227], v2, s[36:39], s18 offen sc1
    buffer_load_dwordx4 v[228:231], v2, s[36:39], s21 offen sc1
    s_cmp_ge_u32 s60, 6
    s_cbranch_scc1 B_nokc
    ds_read_b128 v[44:47], v20 offset:0
    ds_read_b128 v[76:79], v21 offset:0
    ds_read_b128 v[48:51], v20 offset:16
    ds_read_b128 v[80:83], v21 offset:16
    ds_read_b128 v[52:55], v20 offset:32
    ds_read_b128 v[84:87], v21 offset:32
    ds_read_b128 v[56:59], v20 offset:48
    ds_read_b128 v[88:91], v21 offset:48
    s_waitcnt lgkmcnt(6)
    v_mfma_f32_16x16x32_bf16 v[36:39], v[44:47], v[76:79], 0
    ds_read_b128 v[60:63], v20 offset:64
    ds_read_b128 v[92:95], v21 offset:64
    s_waitcnt lgkmcnt(6)
    v_mfma_f32_16x16x32_bf16 v[36:39], v[48:51], v[80:83], v[36:39]
    ds_read_b128 v[64:67], v20 offset:80
    ds_read_b128 v[96:99], v21 offset:80
    s_waitcnt lgkmcnt(6)
    v_mfma_f32_16x16x32_bf16 v[36:39], v[52:55], v[84:87], v[36:39]
    ds_read_b128 v[68:71], v20 offset:96
    ds_read_b128 v[100:103], v21 offset:96
    s_waitcnt lgkmcnt(6)
    v_mfma_f32_16x16x32_bf16 v[36:39], v[56:59], v[88:91], v[36:39]
    ds_read_b128 v[72:75], v20 offset:112
    ds_read_b128 v[104:107], v21 offset:112
    s_waitcnt lgkmcnt(6)
    v_mfma_f32_16x16x32_bf16 v[36:39], v[60:63], v[92:95], v[36:39]
    s_waitcnt lgkmcnt(4)
    v_mfma_f32_16x16x32_bf16 v[36:39], v[64:67], v[96:99], v[36:39]
    s_waitcnt lgkmcnt(2)
    v_mfma_f32_16x16x32_bf16 v[36:39], v[68:71], v[100:103], v[36:39]
    s_waitcnt lgkmcnt(0)
    v_mfma_f32_16x16x32_bf16 v[36:39], v[72:75], v[104:107], v[36:39]
    s_nop 7
    v_cvt_pk_bf16_f32 v34, v36, v37
    v_cvt_pk_bf16_f32 v35, v38, v39
    ds_write_b32 v22, v34
    ds_write_b32 v23, v35
B_nokc:
    s_waitcnt lgkmcnt(0)
    s_barrier
    buffer_load_dwordx4 v[232:235], v3, s[40:43], 0 offen sc1
    buffer_load_dwordx4 v[236:239], v3, s[40:43], s20 offen sc1
    ds_read_u16 v44, v24 offset:33552
    ds_read_u16 v45, v25 offset:33552
    ds_read_u16 v46, v26 offset:33552
    ds_read_u16 v47, v27 offset:33552
    ds_read_u16 v48, v28 offset:33552
    ds_read_u16 v49, v29 offset:33552
    ds_read_u16 v50, v30 offset:33552
    ds_read_u16 v51, v31 offset:33552
    ds_read_u16 v52, v32 offset:33552
    s_lshl_b32 s56, s23, 16
    s_and_b32 s58, s23, 0xffff0000
    s_mov_b32 s63, 262144
    s_waitcnt lgkmcnt(0)
    v_lshl_or_b32 v56, v45, 16, v44
    v_lshl_or_b32 v57, v47, 16, v46
    v_lshl_or_b32 v58, v49, 16, v48
    v_lshl_or_b32 v59, v51, 16, v50
    ds_write_b128 v214, v[56:59]
    v_lshl_or_b32 v60, v46, 16, v45
    v_lshl_or_b32 v61, v48, 16, v47
    v_lshl_or_b32 v62, v50, 16, v49
    v_lshl_or_b32 v63, v52, 16, v51
    ds_write_b128 v214, v[60:63] offset:4160
    s_waitcnt lgkmcnt(0)
    s_barrier
    s_cmp_eq_u32 s59, 1
    s_cbranch_scc1 B_noa
    ds_read2_b32 v[68:69], v208 offset0:128 offset1:129
    ds_read2_b32 v[70:71], v208 offset0:130 offset1:131
    ds_read2_b32 v[72:73], v208 offset0:0 offset1:1
    ds_read2_b32 v[74:75], v208 offset0:2 offset1:3
    ds_read2_b32 v[76:77], v209 offset0:128 offset1:129
    ds_read2_b32 v[78:79], v209 offset0:130 offset1:131
    ds_read2_b32 v[80:81], v209 offset0:0 offset1:1
    ds_read2_b32 v[82:83], v209 offset0:2 offset1:3
    ds_read2_b32 v[84:85], v208 offset0:144 offset1:145
    ds_read2_b32 v[86:87], v208 offset0:146 offset1:147
    ds_read2_b32 v[88:89], v208 offset0:16 offset1:17
    ds_read2_b32 v[90:91], v208 offset0:18 offset1:19
    ds_read2_b32 v[92:93], v209 offset0:144 offset1:145
    ds_read2_b32 v[94:95], v209 offset0:146 offset1:147
    ds_read2_b32 v[96:97], v209 offset0:16 offset1:17
    ds_read2_b32 v[98:99], v209 offset0:18 offset1:19
B_noa:
    s_waitcnt vmcnt(2)
B_chk1:
    v_cmp_ne_u64 vcc, v[226:227], v[220:221]
    v_cmp_ne_u64 s[8:9], v[230:231], v[220:221]
    s_nop 0
    s_or_b64 vcc, vcc, s[8:9]
    s_cbranch_scc0 B_have1
    s_mov_b64 exec, vcc
    buffer_load_dwordx4 v[224:227], v2, s[36:39], s18 offen sc1
    buffer_load_dwordx4 v[228:231], v2, s[36:39], s21 offen sc1
    s_waitcnt vmcnt(0)
    s_sub_u32 s63, s63, 1
    s_cbranch_scc0 B_chk1
    s_mov_b32 s63, 0
B_have1:
    s_mov_b64 exec, -1
    v_lshlrev_b32 v196, 16, v224
    v_and_b32 v200, 0xffff0000, v224
    v_lshlrev_b32 v197, 16, v225
    v_and_b32 v201, 0xffff0000, v225
    v_lshlrev_b32 v198, 16, v228
    v_and_b32 v202, 0xffff0000, v228
    v_lshlrev_b32 v199, 16, v229
    v_and_b32 v203, 0xffff0000, v229
    s_waitcnt vmcnt(0)
B_chk2:
    v_cmp_ne_u64 vcc, v[234:235], v[220:221]
    v_cmp_ne_u64 s[8:9], v[238:239], v[220:221]
    v_and_b32 v12, 0xffff0000, v232
    v_and_b32 v13, 0xffff0000, v233
    v_and_b32 v14, 0xffff0000, v236
    v_and_b32 v15, 0xffff0000, v237
    s_or_b64 vcc, vcc, s[8:9]
    s_cbranch_scc0 B_have2
    s_mov_b64 exec, vcc
    buffer_load_dwordx4 v[232:235], v3, s[40:43], 0 offen sc1
    buffer_load_dwordx4 v[236:239], v3, s[40:43], s20 offen sc1
    s_waitcnt vmcnt(0)
    s_sub_u32 s63, s63, 1
    s_cbranch_scc0 B_chk2
    s_mov_b32 s63, 0
B_have2:
    s_mov_b64 exec, -1
    s_cmp_eq_u32 s59, 1
    s_cbranch_scc0 B_nonh
    s_add_u32 s64, s5, 0
    s_and_b32 s64, s64, 15
    s_add_u32 m0, s6, 102400
    s_mul_i32 s64, s64, 88064
    buffer_load_dwordx4 v240, s[48:51], s64 offen offset:0  lds
    buffer_load_dwordx4 v241, s[48:51], s64 offen offset:1024  lds
    buffer_load_dwordx4 v242, s[48:51], s64 offen offset:2048  lds
B_nonh:
    v_rcp_f32 v12, v12
    v_lshlrev_b32 v16, 16, v232
    v_rcp_f32 v13, v13
    v_lshlrev_b32 v17, 16, v233
    v_rcp_f32 v14, v14
    v_lshlrev_b32 v18, 16, v236
    v_rcp_f32 v15, v15
    v_lshlrev_b32 v19, 16, v237
    v_pk_mul_f32 v[16:17], v[16:17], v[12:13]
    v_pk_mul_f32 v[18:19], v[18:19], v[14:15]
    v_pk_fma_f32 v[44:45], v[196:197], v[12:13], v[16:17]
    v_pk_fma_f32 v[46:47], v[198:199], v[14:15], v[18:19]
    v_cvt_pk_bf16_f32 v52, v44, v45
    v_cvt_pk_bf16_f32 v53, v46, v47
    ds_write2st64_b32 v215, v52, v53 offset0:0 offset1:8
    v_pk_fma_f32 v[48:49], v[200:201], v[12:13], v[16:17]
    v_pk_fma_f32 v[50:51], v[202:203], v[14:15], v[18:19]
    v_cvt_pk_bf16_f32 v54, v48, v49
    v_cvt_pk_bf16_f32 v55, v50, v51
    ds_write2st64_b32 v215, v54, v55 offset0:18 offset1:26
    v_pk_fma_f32 v[196:197], v[44:45], s[56:57], v[196:197] op_sel_hi:[1,0,1]
    v_pk_fma_f32 v[198:199], v[46:47], s[56:57], v[198:199] op_sel_hi:[1,0,1]
    v_pk_fma_f32 v[200:201], v[48:49], s[58:59], v[200:201] op_sel_hi:[1,0,1]
    v_pk_fma_f32 v[202:203], v[50:51], s[58:59], v[202:203] op_sel_hi:[1,0,1]
    s_waitcnt lgkmcnt(0)
    s_barrier
    s_cmp_eq_u32 s59, 1
    s_cbranch_scc1 B_help
    ds_read_b128 v[100:103], v212 offset:0
    ds_read_b128 v[104:107], v212 offset:512
    ds_read_b128 v[108:111], v212 offset:1024
    ds_read_b128 v[112:115], v212 offset:1536
    ds_read_b128 v[116:119], v212 offset:2048
    ds_read_b128 v[120:123], v212 offset:2560
    ds_read_b128 v[124:127], v212 offset:3072
    ds_read_b128 v[128:131], v212 offset:3584
    buffer_store_dwordx4 v[244:247], v248, s[32:35], 0 offen sc1
    buffer_store_dwordx4 v[244:247], v249, s[32:35], 0 offen sc1
    s_waitcnt lgkmcnt(7)
    v_mfma_f32_16x16x32_bf16 v[36:39], v[68:71], v[100:103], 0
    ds_read_b128 v[20:23], v222 offset:432
    v_mfma_f32_16x16x32_bf16 v[40:43], v[72:75], v[100:103], 0
    ds_read_b128 v[24:27], v222 offset:448
    v_mfma_f32_16x16x32_bf16 v[44:47], v[76:79], v[100:103], 0
    ds_read_b128 v[28:31], v222 offset:944
    v_mfma_f32_16x16x32_bf16 v[48:51], v[80:83], v[100:103], 0
    ds_read_b128 v[32:35], v222 offset:960
    s_waitcnt lgkmcnt(10)
    v_mfma_f32_16x16x32_bf16 v[40:43], v[68:71], v[104:107], v[40:43]
    ds_read_b128 v[100:103], v212 offset:64
    v_mfma_f32_16x16x32_bf16 v[44:47], v[72:75], v[104:107], v[44:47]
    ds_read2_b32 v[132:133], v208 offset0:160 offset1:161
    v_mfma_f32_16x16x32_bf16 v[48:51], v[76:79], v[104:107], v[48:51]
    ds_read2_b32 v[134:135], v208 offset0:162 offset1:163
    v_mfma_f32_16x16x32_bf16 v[52:55], v[80:83], v[104:107], 0
    ds_read2_b32 v[136:137], v208 offset0:32 offset1:33
    s_waitcnt lgkmcnt(6)
    v_mfma_f32_16x16x32_bf16 v[44:47], v[68:71], v[108:111], v[44:47]
    ds_read_b128 v[104:107], v212 offset:576
    v_mfma_f32_16x16x32_bf16 v[48:51], v[72:75], v[108:111], v[48:51]
    ds_read2_b32 v[138:139], v208 offset0:34 offset1:35
    v_mfma_f32_16x16x32_bf16 v[52:55], v[76:79], v[108:111], v[52:55]
    ds_read2_b32 v[140:141], v209 offset0:160 offset1:161
    v_mfma_f32_16x16x32_bf16 v[56:59], v[80:83], v[108:111], 0
    ds_read2_b32 v[142:143], v209 offset0:162 offset1:163
    v_mfma_f32_16x16x32_bf16 v[48:51], v[68:71], v[112:115], v[48:51]
    ds_read_b128 v[108:111], v212 offset:1088
    v_mfma_f32_16x16x32_bf16 v[52:55], v[72:75], v[112:115], v[52:55]
    ds_read2_b32 v[144:145], v209 offset0:32 offset1:33
    v_mfma_f32_16x16x32_bf16 v[56:59], v[76:79], v[112:115], v[56:59]
    ds_read2_b32 v[146:147], v209 offset0:34 offset1:35
    v_mfma_f32_16x16x32_bf16 v[60:63], v[80:83], v[112:115], 0
    ds_read2_b32 v[148:149], v208 offset0:176 offset1:177
    v_mfma_f32_16x16x32_bf16 v[52:55], v[68:71], v[116:119], v[52:55]
    ds_read_b128 v[112:115], v212 offset:1600
    v_mfma_f32_16x16x32_bf16 v[56:59], v[72:75], v[116:119], v[56:59]
    ds_read2_b32 v[150:151], v208 offset0:178 offset1:179
    v_mfma_f32_16x16x32_bf16 v[60:63], v[76:79], v[116:119], v[60:63]
    ds_read2_b32 v[152:153], v208 offset0:48 offset1:49
    v_mfma_f32_16x16x32_bf16 v[64:67], v[80:83], v[116:119], 0
    ds_read2_b32 v[154:155], v208 offset0:50 offset1:51
    v_mfma_f32_16x16x32_bf16 v[56:59], v[68:71], v[120:123], v[56:59]
    ds_read_b128 v[116:119], v212 offset:2112
    v_mfma_f32_16x16x32_bf16 v[60:63], v[72:75], v[120:123], v[60:63]
    ds_read2_b32 v[156:157], v209 offset0:176 offset1:177
    v_mfma_f32_16x16x32_bf16 v[64:67], v[76:79], v[120:123], v[64:67]
    ds_read2_b32 v[158:159], v209 offset0:178 offset1:179
    v_mfma_f32_16x16x32_bf16 v[60:63], v[68:71], v[124:127], v[60:63]
    ds_read_b128 v[120:123], v212 offset:2624
    v_mfma_f32_16x16x32_bf16 v[64:67], v[72:75], v[124:127], v[64:67]
    ds_read2_b32 v[160:161], v209 offset0:48 offset1:49
    v_mfma_f32_16x16x32_bf16 v[64:67], v[68:71], v[128:131], v[64:67]
    ds_read_b128 v[124:127], v212 offset:3136
    s_waitcnt lgkmcnt(6)
    v_mfma_f32_16x16x32_bf16 v[224:227], v[20:23], v[192:195], 0
    v_mfma_f32_16x16x32_bf16 v[228:231], v[24:27], v[204:207], 0
    v_mfma_f32_16x16x32_bf16 v[232:235], v[28:31], v[192:195], 0
    v_mfma_f32_16x16x32_bf16 v[236:239], v[32:35], v[204:207], 0
    v_mfma_f32_16x16x32_bf16 v[36:39], v[84:87], v[100:103], v[36:39]
    ds_read_b128 v[128:131], v212 offset:3648
    v_mfma_f32_16x16x32_bf16 v[40:43], v[88:91], v[100:103], v[40:43]
    ds_read2_b32 v[162:163], v209 offset0:50 offset1:51
    v_mfma_f32_16x16x32_bf16 v[44:47], v[92:95], v[100:103], v[44:47]
    ds_read2_b32 v[164:165], v210 offset0:176 offset1:177
    v_mfma_f32_16x16x32_bf16 v[48:51], v[96:99], v[100:103], v[48:51]
    ds_read2_b32 v[166:167], v210 offset0:178 offset1:179
    v_mfma_f32_16x16x32_bf16 v[40:43], v[84:87], v[104:107], v[40:43]
    ds_read_b128 v[100:103], v212 offset:128
    v_mfma_f32_16x16x32_bf16 v[44:47], v[88:91], v[104:107], v[44:47]
    ds_read2_b32 v[168:169], v211 offset0:48 offset1:49
    v_mfma_f32_16x16x32_bf16 v[48:51], v[92:95], v[104:107], v[48:51]
    ds_read2_b32 v[170:171], v211 offset0:50 offset1:51
    v_mfma_f32_16x16x32_bf16 v[52:55], v[96:99], v[104:107], v[52:55]
    ds_read2_b32 v[172:173], v211 offset0:32 offset1:33
    v_mfma_f32_16x16x32_bf16 v[44:47], v[84:87], v[108:111], v[44:47]
    ds_read_b128 v[104:107], v212 offset:640
    v_mfma_f32_16x16x32_bf16 v[48:51], v[88:91], v[108:111], v[48:51]
    ds_read2_b32 v[174:175], v211 offset0:34 offset1:35
    v_mfma_f32_16x16x32_bf16 v[52:55], v[92:95], v[108:111], v[52:55]
    ds_read2_b32 v[176:177], v211 offset0:16 offset1:17
    v_mfma_f32_16x16x32_bf16 v[56:59], v[96:99], v[108:111], v[56:59]
    ds_read2_b32 v[178:179], v211 offset0:18 offset1:19
    v_mfma_f32_16x16x32_bf16 v[48:51], v[84:87], v[112:115], v[48:51]
    ds_read_b128 v[108:111], v212 offset:1152
    v_mfma_f32_16x16x32_bf16 v[52:55], v[88:91], v[112:115], v[52:55]
    ds_read2_b32 v[180:181], v211 offset0:0 offset1:1
    v_mfma_f32_16x16x32_bf16 v[56:59], v[92:95], v[112:115], v[56:59]
    ds_read2_b32 v[182:183], v211 offset0:2 offset1:3
    v_mfma_f32_16x16x32_bf16 v[60:63], v[96:99], v[112:115], v[60:63]
    ds_write_b64 v213, v[196:197] offset:36864
    s_waitcnt lgkmcnt(6)
    v_mfma_f32_16x16x32_bf16 v[52:55], v[84:87], v[116:119], v[52:55]
    ds_read_b128 v[112:115], v212 offset:1664
    v_mfma_f32_16x16x32_bf16 v[56:59], v[88:91], v[116:119], v[56:59]
    ds_write_b64 v213, v[198:199] offset:40960
    v_mfma_f32_16x16x32_bf16 v[60:63], v[92:95], v[116:119], v[60:63]
    ds_write_b64 v213, v[200:201] offset:45056
    v_mfma_f32_16x16x32_bf16 v[64:67], v[96:99], v[116:119], v[64:67]
    ds_write_b64 v213, v[202:203] offset:49152
    v_mfma_f32_16x16x32_bf16 v[56:59], v[84:87], v[120:123], v[56:59]
    ds_read_b128 v[116:119], v212 offset:2176
    v_mfma_f32_16x16x32_bf16 v[60:63], v[88:91], v[120:123], v[60:63]
    v_cvt_pk_bf16_f32 v184, v224, v228
    v_mfma_f32_16x16x32_bf16 v[64:67], v[92:95], v[120:123], v[64:67]
    v_cvt_pk_bf16_f32 v185, v225, v229
    v_mfma_f32_16x16x32_bf16 v[60:63], v[84:87], v[124:127], v[60:63]
    ds_read_b128 v[120:123], v212 offset:2688
    v_mfma_f32_16x16x32_bf16 v[64:67], v[88:91], v[124:127], v[64:67]
    v_cvt_pk_bf16_f32 v186, v226, v230
    v_mfma_f32_16x16x32_bf16 v[64:67], v[84:87], v[128:131], v[64:67]
    ds_read_b128 v[124:127], v212 offset:3200
    v_mfma_f32_16x16x32_bf16 v[36:39], v[132:135], v[100:103], v[36:39]
    ds_read_b128 v[128:131], v212 offset:3712
    v_mfma_f32_16x16x32_bf16 v[40:43], v[136:139], v[100:103], v[40:43]
    v_cvt_pk_bf16_f32 v187, v227, v231
    v_mfma_f32_16x16x32_bf16 v[44:47], v[140:143], v[100:103], v[44:47]
    v_cvt_pk_bf16_f32 v188, v232, v236
    v_mfma_f32_16x16x32_bf16 v[48:51], v[144:147], v[100:103], v[48:51]
    v_cvt_pk_bf16_f32 v189, v233, v237
    v_mfma_f32_16x16x32_bf16 v[40:43], v[132:135], v[104:107], v[40:43]
    ds_read_b128 v[100:103], v212 offset:192
    v_mfma_f32_16x16x32_bf16 v[44:47], v[136:139], v[104:107], v[44:47]
    v_cvt_pk_bf16_f32 v190, v234, v238
    v_mfma_f32_16x16x32_bf16 v[48:51], v[140:143], v[104:107], v[48:51]
    v_cvt_pk_bf16_f32 v191, v235, v239
    v_mfma_f32_16x16x32_bf16 v[52:55], v[144:147], v[104:107], v[52:55]
    v_lshl_add_u32 v19, s60, 11, v1
    s_waitcnt lgkmcnt(1)
    v_mfma_f32_16x16x32_bf16 v[44:47], v[132:135], v[108:111], v[44:47]
    ds_read_b128 v[104:107], v212 offset:704
    v_mfma_f32_16x16x32_bf16 v[48:51], v[136:139], v[108:111], v[48:51]
    v_xor_b32 v18, 4096, v19
    v_mfma_f32_16x16x32_bf16 v[52:55], v[140:143], v[108:111], v[52:55]
    v_lshlrev_b32 v17, 6, v216
    v_mfma_f32_16x16x32_bf16 v[56:59], v[144:147], v[108:111], v[56:59]
    v_lshl_add_u32 v17, v217, 4, v17
    v_mfma_f32_16x16x32_bf16 v[48:51], v[132:135], v[112:115], v[48:51]
    ds_read_b128 v[108:111], v212 offset:1216
    v_mfma_f32_16x16x32_bf16 v[52:55], v[136:139], v[112:115], v[52:55]
    v_lshl_add_u32 v17, s60, 12, v17
    v_mfma_f32_16x16x32_bf16 v[56:59], v[140:143], v[112:115], v[56:59]
    v_lshrrev_b32 v6, 1, v216
    v_mfma_f32_16x16x32_bf16 v[60:63], v[144:147], v[112:115], v[60:63]
    v_and_b32 v7, 1, v217
    v_mfma_f32_16x16x32_bf16 v[52:55], v[132:135], v[116:119], v[52:55]
    ds_read_b128 v[112:115], v212 offset:1728
    v_mfma_f32_16x16x32_bf16 v[56:59], v[136:139], v[116:119], v[56:59]
    v_lshl_add_u32 v6, v7, 3, v6
    v_mfma_f32_16x16x32_bf16 v[60:63], v[140:143], v[116:119], v[60:63]
    v_mul_u32_u24 v6, 33280, v6
    v_mfma_f32_16x16x32_bf16 v[64:67], v[144:147], v[116:119], v[64:67]
    v_and_b32 v7, 1, v216
    v_mfma_f32_16x16x32_bf16 v[56:59], v[132:135], v[120:123], v[56:59]
    ds_read_b128 v[116:119], v212 offset:2240
    v_mfma_f32_16x16x32_bf16 v[60:63], v[136:139], v[120:123], v[60:63]
    v_lshl_add_u32 v6, v7, 5, v6
    v_mfma_f32_16x16x32_bf16 v[64:67], v[140:143], v[120:123], v[64:67]
    v_lshrrev_b32 v7, 1, v217
    v_mfma_f32_16x16x32_bf16 v[60:63], v[132:135], v[124:127], v[60:63]
    ds_read_b128 v[120:123], v212 offset:2752
    v_mfma_f32_16x16x32_bf16 v[64:67], v[136:139], v[124:127], v[64:67]
    v_lshl_add_u32 v6, v7, 4, v6
    v_mfma_f32_16x16x32_bf16 v[64:67], v[132:135], v[128:131], v[64:67]
    ds_read_b128 v[124:127], v212 offset:3264
    s_mul_i32 s64, s61, 16640
    s_add_u32 s63, s18, s64
    s_mul_i32 s64, s62, 1064960
    s_add_u32 s63, s63, s64
    v_lshrrev_b32 v7, 1, v216
    v_lshlrev_b32 v7, 11, v7
    v_xor_b32 v7, s22, v7
    v_add_u32 v6, v6, v7
    s_cmp_eq_u32 s62, 1
    s_cbranch_scc1 B_x1
    s_waitcnt lgkmcnt(3)
    v_mfma_f32_16x16x32_bf16 v[52:55], v[160:163], v[104:107], v[52:55]
    ds_read_b128 v[128:131], v212 offset:3776
    v_mfma_f32_16x16x32_bf16 v[52:55], v[156:159], v[108:111], v[52:55]
    v_mfma_f32_16x16x32_bf16 v[56:59], v[160:163], v[108:111], v[56:59]
    v_mfma_f32_16x16x32_bf16 v[52:55], v[152:155], v[112:115], v[52:55]
    v_mfma_f32_16x16x32_bf16 v[56:59], v[156:159], v[112:115], v[56:59]
    v_mfma_f32_16x16x32_bf16 v[60:63], v[160:163], v[112:115], v[60:63]
    s_waitcnt lgkmcnt(1)
    v_mfma_f32_16x16x32_bf16 v[52:55], v[148:151], v[116:119], v[52:55]
    v_mfma_f32_16x16x32_bf16 v[56:59], v[152:155], v[116:119], v[56:59]
    v_mfma_f32_16x16x32_bf16 v[60:63], v[156:159], v[116:119], v[60:63]
    v_mfma_f32_16x16x32_bf16 v[64:67], v[160:163], v[116:119], v[64:67]
    v_mfma_f32_16x16x32_bf16 v[56:59], v[148:151], v[120:123], v[56:59]
    v_mfma_f32_16x16x32_bf16 v[60:63], v[152:155], v[120:123], v[60:63]
    v_mfma_f32_16x16x32_bf16 v[64:67], v[156:159], v[120:123], v[64:67]
    v_mfma_f32_16x16x32_bf16 v[60:63], v[148:151], v[124:127], v[60:63]
    v_mfma_f32_16x16x32_bf16 v[64:67], v[152:155], v[124:127], v[64:67]
    s_waitcnt lgkmcnt(0)
    v_mfma_f32_16x16x32_bf16 v[64:67], v[148:151], v[128:131], v[64:67]
    v_mfma_f32_16x16x32_bf16 v[52:55], v[184:187], v[168:171], v[52:55]
    v_mfma_f32_16x16x32_bf16 v[56:59], v[184:187], v[172:175], v[56:59]
    v_mfma_f32_16x16x32_bf16 v[60:63], v[184:187], v[176:179], v[60:63]
    v_mfma_f32_16x16x32_bf16 v[64:67], v[184:187], v[180:183], v[64:67]
    v_mfma_f32_16x16x32_bf16 v[56:59], v[188:191], v[168:171], v[56:59]
    v_mfma_f32_16x16x32_bf16 v[60:63], v[188:191], v[172:175], v[60:63]
    v_mfma_f32_16x16x32_bf16 v[64:67], v[188:191], v[176:179], v[64:67]
    v_mfma_f32_16x16x32_bf16 v[36:39], v[148:151], v[100:103], v[36:39]
    v_mfma_f32_16x16x32_bf16 v[40:43], v[152:155], v[100:103], v[40:43]
    v_mfma_f32_16x16x32_bf16 v[44:47], v[156:159], v[100:103], v[44:47]
    ds_write_b128 v19, v[52:55] offset:53248
    v_mfma_f32_16x16x32_bf16 v[48:51], v[160:163], v[100:103], v[48:51]
    s_nop 0
    ds_write_b128 v19, v[56:59] offset:54272
    v_mfma_f32_16x16x32_bf16 v[40:43], v[148:151], v[104:107], v[40:43]
    ds_write_b128 v19, v[60:63] offset:55296
    v_mfma_f32_16x16x32_bf16 v[44:47], v[152:155], v[104:107], v[44:47]
    ds_write_b128 v19, v[64:67] offset:56320
    v_mfma_f32_16x16x32_bf16 v[48:51], v[156:159], v[104:107], v[48:51]
    v_mfma_f32_16x16x32_bf16 v[44:47], v[148:151], v[108:111], v[44:47]
    v_mfma_f32_16x16x32_bf16 v[48:51], v[152:155], v[108:111], v[48:51]
    v_mfma_f32_16x16x32_bf16 v[48:51], v[148:151], v[112:115], v[48:51]
    s_branch B_x2
B_x1:
    s_waitcnt lgkmcnt(3)
    v_mfma_f32_16x16x32_bf16 v[36:39], v[148:151], v[100:103], v[36:39]
    ds_read_b128 v[128:131], v212 offset:3776
    v_mfma_f32_16x16x32_bf16 v[40:43], v[152:155], v[100:103], v[40:43]
    v_mfma_f32_16x16x32_bf16 v[44:47], v[156:159], v[100:103], v[44:47]
    v_mfma_f32_16x16x32_bf16 v[48:51], v[160:163], v[100:103], v[48:51]
    v_mfma_f32_16x16x32_bf16 v[40:43], v[148:151], v[104:107], v[40:43]
    v_mfma_f32_16x16x32_bf16 v[44:47], v[152:155], v[104:107], v[44:47]
    v_mfma_f32_16x16x32_bf16 v[48:51], v[156:159], v[104:107], v[48:51]
    v_mfma_f32_16x16x32_bf16 v[44:47], v[148:151], v[108:111], v[44:47]
    v_mfma_f32_16x16x32_bf16 v[48:51], v[152:155], v[108:111], v[48:51]
    v_mfma_f32_16x16x32_bf16 v[48:51], v[148:151], v[112:115], v[48:51]
    v_mfma_f32_16x16x32_bf16 v[52:55], v[164:167], v[100:103], v[52:55]
    v_mfma_f32_16x16x32_bf16 v[52:55], v[160:163], v[104:107], v[52:55]
    v_mfma_f32_16x16x32_bf16 v[56:59], v[164:167], v[104:107], v[56:59]
    ds_write_b128 v19, v[36:39] offset:53248
    v_mfma_f32_16x16x32_bf16 v[52:55], v[156:159], v[108:111], v[52:55]
    ds_write_b128 v19, v[40:43] offset:54272
    v_mfma_f32_16x16x32_bf16 v[56:59], v[160:163], v[108:111], v[56:59]
    ds_write_b128 v19, v[44:47] offset:55296
    v_mfma_f32_16x16x32_bf16 v[60:63], v[164:167], v[108:111], v[60:63]
    ds_write_b128 v19, v[48:51] offset:56320
    v_mfma_f32_16x16x32_bf16 v[52:55], v[152:155], v[112:115], v[52:55]
    v_mfma_f32_16x16x32_bf16 v[56:59], v[156:159], v[112:115], v[56:59]
    v_mfma_f32_16x16x32_bf16 v[60:63], v[160:163], v[112:115], v[60:63]
    v_mfma_f32_16x16x32_bf16 v[64:67], v[164:167], v[112:115], v[64:67]
    s_waitcnt lgkmcnt(2)
    v_mfma_f32_16x16x32_bf16 v[52:55], v[148:151], v[116:119], v[52:55]
    v_mfma_f32_16x16x32_bf16 v[56:59], v[152:155], v[116:119], v[56:59]
    v_mfma_f32_16x16x32_bf16 v[60:63], v[156:159], v[116:119], v[60:63]
    v_mfma_f32_16x16x32_bf16 v[64:67], v[160:163], v[116:119], v[64:67]
    v_mfma_f32_16x16x32_bf16 v[56:59], v[148:151], v[120:123], v[56:59]
    v_mfma_f32_16x16x32_bf16 v[60:63], v[152:155], v[120:123], v[60:63]
    v_mfma_f32_16x16x32_bf16 v[64:67], v[156:159], v[120:123], v[64:67]
    v_mfma_f32_16x16x32_bf16 v[60:63], v[148:151], v[124:127], v[60:63]
    v_mfma_f32_16x16x32_bf16 v[64:67], v[152:155], v[124:127], v[64:67]
    v_mfma_f32_16x16x32_bf16 v[64:67], v[148:151], v[128:131], v[64:67]
    v_mfma_f32_16x16x32_bf16 v[60:63], v[184:187], v[168:171], v[60:63]
    v_mfma_f32_16x16x32_bf16 v[64:67], v[184:187], v[172:175], v[64:67]
    v_mfma_f32_16x16x32_bf16 v[64:67], v[188:191], v[168:171], v[64:67]
B_x2:
    s_waitcnt lgkmcnt(0)
    s_barrier
    ds_read_b128 v[68:71], v18 offset:53248
    ds_read_b128 v[72:75], v17 offset:36864
    ds_read_b128 v[76:79], v18 offset:54272
    ds_read_b128 v[80:83], v17 offset:37888
    ds_read_b128 v[84:87], v18 offset:55296
    ds_read_b128 v[88:91], v17 offset:38912
    ds_read_b128 v[92:95], v18 offset:56320
    ds_read_b128 v[96:99], v17 offset:39936
    s_cmp_eq_u32 s62, 0
    s_cbranch_scc1 B_x4
    v_mov_b64 v[36:37], v[52:53]
    v_mov_b64 v[38:39], v[54:55]
    v_mov_b64 v[40:41], v[56:57]
    v_mov_b64 v[42:43], v[58:59]
    v_mov_b64 v[44:45], v[60:61]
    v_mov_b64 v[46:47], v[62:63]
    v_mov_b64 v[48:49], v[64:65]
    v_mov_b64 v[50:51], v[66:67]
B_x4:
    s_waitcnt lgkmcnt(6)
    v_pk_add_f32 v[36:37], v[36:37], v[68:69]
    v_pk_add_f32 v[38:39], v[38:39], v[70:71]
    v_pk_add_f32 v[36:37], v[36:37], v[72:73]
    v_pk_add_f32 v[38:39], v[38:39], v[74:75]
    v_cvt_pk_bf16_f32 v100, v36, v37
    v_cvt_pk_bf16_f32 v101, v38, v39
    s_waitcnt lgkmcnt(4)
    v_pk_add_f32 v[40:41], v[40:41], v[76:77]
    v_pk_add_f32 v[42:43], v[42:43], v[78:79]
    v_pk_add_f32 v[40:41], v[40:41], v[80:81]
    v_pk_add_f32 v[42:43], v[42:43], v[82:83]
    v_cvt_pk_bf16_f32 v102, v40, v41
    v_cvt_pk_bf16_f32 v103, v42, v43
    s_nop 0
    v_permlane16_swap_b32 v100, v102
    v_permlane16_swap_b32 v101, v103
    buffer_store_dwordx4 v[100:103], v6, s[44:47], s63 offen offset:1024 sc1
    s_add_u32 s63, s63, 532480
    s_waitcnt lgkmcnt(2)
    v_pk_add_f32 v[44:45], v[44:45], v[84:85]
    v_pk_add_f32 v[46:47], v[46:47], v[86:87]
    v_pk_add_f32 v[44:45], v[44:45], v[88:89]
    v_pk_add_f32 v[46:47], v[46:47], v[90:91]
    v_cvt_pk_bf16_f32 v104, v44, v45
    v_cvt_pk_bf16_f32 v105, v46, v47
    s_waitcnt lgkmcnt(0)
    v_pk_add_f32 v[48:49], v[48:49], v[92:93]
    v_pk_add_f32 v[50:51], v[50:51], v[94:95]
    v_pk_add_f32 v[48:49], v[48:49], v[96:97]
    v_pk_add_f32 v[50:51], v[50:51], v[98:99]
    v_cvt_pk_bf16_f32 v106, v48, v49
    v_cvt_pk_bf16_f32 v107, v50, v51
    s_nop 0
    v_permlane16_swap_b32 v104, v106
    v_permlane16_swap_b32 v105, v107
    buffer_store_dwordx4 v[104:107], v6, s[44:47], s63 offen offset:1024 sc1
    s_barrier
    s_setprio 2
    s_and_b32 s16, s2, 3
    s_lshl_b32 s16, s16, 2
    s_lshr_b32 s17, s2, 6
    s_add_u32 s16, s16, s17
    s_bfe_u32 s5, s2, 0x30003
    s_and_b32 s17, s2, 4
    s_lshl_b32 s17, s17, 1
    s_add_u32 s17, s17, s5
    s_mul_i32 s63, s5, 4
    s_lshr_b32 s63, s63, 3
    s_lshl_b32 s63, s63, 2
    s_add_u32 s63, s63, 3
    s_cmp_eq_u32 s16, s63
    s_cselect_b32 s16, 16, s16
    s_cmp_gt_u32 s16, s63
    s_subb_u32 s16, s16, 0
    s_lshl_b32 s5, s5, 1
    s_mov_b32 s3, s17
    v_and_b32 v1, 63, v0
    v_lshlrev_b32 v2, 4, v1
    s_mul_i32 s38, s16, 6
    s_mul_i32 s39, s62, 3
    s_add_u32 s38, s38, s39
    s_add_u32 s32, s30, 0x20000
    s_addc_u32 s33, s31, 0
    s_mov_b32 s34, 0x15800
    s_mov_b32 s35, 0x20000
    s_add_u32 s24, s30, 0x510000
    s_addc_u32 s25, s31, 0
    s_mov_b32 s26, 0x560000
    s_mov_b32 s27, 0x20000
    s_lshl_b32 s36, s38, 10
    s_lshl_b32 s8, s3, 1
    s_add_u32 s8, s8, s61
    s_lshl_b32 s48, s8, 8
    s_add_u32 s48, s48, 219136
    s_mul_i32 s8, s8, 172
    s_lshl_b32 s9, s16, 1
    s_add_u32 s9, s9, s62
    s_add_u32 s8, s8, s9
    s_cmp_le_u32 s9, 14
    s_cselect_b32 s10, 0, 28
    s_add_u32 s10, s10, s8
    s_lshl_b32 s52, s10, 10
    s_add_u32 s53, s52, 88064
    s_cmp_le_u32 s9, 13
    s_cselect_b32 s10, 15, 43
    s_add_u32 s10, s10, s8
    s_lshl_b32 s54, s10, 10
    s_add_u32 s55, s54, 88064
    s_cmp_le_u32 s9, 13
    s_cselect_b32 s10, 29, 58
    s_add_u32 s10, s10, s8
    s_lshl_b32 s56, s10, 10
    s_add_u32 s57, s56, 88064
    v_mov_b64 v[244:245], -1
    v_mov_b64 v[246:247], -1
    s_cmp_ge_u32 s38, 84
    s_cselect_b32 s10, 0x7fffffff, 0
    v_or_b32 v3, s10, v2
    s_cmp_ge_u32 s38, 86
    s_cselect_b32 s10, 0x7fffffff, 0
    v_or_b32 v4, s10, v2
    v_lshrrev_b32 v6, 5, v1
    v_bfe_u32 v7, v1, 2, 2
    v_lshl_add_u32 v6, v6, 3, v7
    v_bfe_u32 v7, v1, 4, 1
    v_and_b32 v8, 3, v1
    v_lshlrev_b32 v9, 6, v6
    v_lshl_add_u32 v9, v7, 5, v9
    v_lshl_add_u32 v9, v8, 3, v9
    v_lshl_add_u32 v9, s61, 12, v9
    v_add_u32 v172, 36864, v9
    v_lshlrev_b32 v9, 1, v8
    v_lshrrev_b32 v8, 1, v8
    v_or_b32 v8, v8, v9
    v_and_b32 v8, 3, v8
    v_mul_u32_u24 v9, 192, v6
    v_lshl_add_u32 v9, v8, 3, v9
    v_mul_u32_u24 v8, 6144, v7
    v_add_u32 v9, v9, v8
    s_add_u32 s8, s39, 0
    v_xor_b32 v8, s8, v7
    v_lshl_add_u32 v174, v8, 5, v9
    v_add_u32 v177, 102400, v174
    s_add_u32 s8, s39, 1
    v_xor_b32 v8, s8, v7
    v_lshl_add_u32 v175, v8, 5, v9
    v_add_u32 v178, 102400, v175
    s_add_u32 s8, s39, 2
    v_xor_b32 v8, s8, v7
    v_lshl_add_u32 v176, v8, 5, v9
    v_add_u32 v179, 102400, v176
    v_and_b32 v18, 31, v1
    v_lshlrev_b32 v18, 2, v18
    s_waitcnt vmcnt(0)
    s_barrier
    s_cmp_eq_u32 s16, 15
    s_cbranch_scc1 F_stat
    s_bfe_u32 s17, s2, 0x10002
    v_lshrrev_b32 v5, 2, v1
    v_mul_u32_u24 v5, 192, v5
    s_lshl_b32 s14, s17, 1
    v_and_b32 v6, 3, v1
    v_xor_b32 v6, s14, v6
    v_lshl_add_u32 v5, v6, 4, v5
    s_mul_i32 s14, s17, 6144
    s_lshl_b32 s15, s19, 6
    s_add_u32 s14, s14, s15
    s_add_u32 s14, s14, 102400
    v_add_u32 v5, s14, v5
    ds_read_b128 v[108:111], v5 offset:0
    ds_read_b128 v[112:115], v5 offset:3072
    ds_read_b128 v[116:119], v5 offset:12288
    ds_read_b128 v[120:123], v5 offset:15360
    s_waitcnt lgkmcnt(0)
    v_lshlrev_b32 v36, 16, v108
    v_and_b32 v37, 0xffff0000, v108
    v_lshlrev_b32 v38, 16, v109
    v_and_b32 v39, 0xffff0000, v109
    v_lshlrev_b32 v40, 16, v110
    v_and_b32 v41, 0xffff0000, v110
    v_lshlrev_b32 v42, 16, v111
    v_and_b32 v43, 0xffff0000, v111
    v_lshlrev_b32 v44, 16, v112
    v_and_b32 v45, 0xffff0000, v112
    v_add_f32 v36, v36, v44
    v_add_f32 v37, v37, v45
    v_lshlrev_b32 v44, 16, v113
    v_and_b32 v45, 0xffff0000, v113
    v_add_f32 v38, v38, v44
    v_add_f32 v39, v39, v45
    v_lshlrev_b32 v44, 16, v114
    v_and_b32 v45, 0xffff0000, v114
    v_add_f32 v40, v40, v44
    v_add_f32 v41, v41, v45
    v_lshlrev_b32 v44, 16, v115
    v_and_b32 v45, 0xffff0000, v115
    v_add_f32 v42, v42, v44
    v_add_f32 v43, v43, v45
    v_lshlrev_b32 v44, 16, v116
    v_and_b32 v45, 0xffff0000, v116
    v_add_f32 v36, v36, v44
    v_add_f32 v37, v37, v45
    v_lshlrev_b32 v44, 16, v117
    v_and_b32 v45, 0xffff0000, v117
    v_add_f32 v38, v38, v44
    v_add_f32 v39, v39, v45
    v_lshlrev_b32 v44, 16, v118
    v_and_b32 v45, 0xffff0000, v118
    v_add_f32 v40, v40, v44
    v_add_f32 v41, v41, v45
    v_lshlrev_b32 v44, 16, v119
    v_and_b32 v45, 0xffff0000, v119
    v_add_f32 v42, v42, v44
    v_add_f32 v43, v43, v45
    v_lshlrev_b32 v44, 16, v120
    v_and_b32 v45, 0xffff0000, v120
    v_add_f32 v36, v36, v44
    v_add_f32 v37, v37, v45
    v_lshlrev_b32 v44, 16, v121
    v_and_b32 v45, 0xffff0000, v121
    v_add_f32 v38, v38, v44
    v_add_f32 v39, v39, v45
    v_lshlrev_b32 v44, 16, v122
    v_and_b32 v45, 0xffff0000, v122
    v_add_f32 v40, v40, v44
    v_add_f32 v41, v41, v45
    v_lshlrev_b32 v44, 16, v123
    v_and_b32 v45, 0xffff0000, v123
    v_add_f32 v42, v42, v44
    v_add_f32 v43, v43, v45
    v_permlane32_swap_b32 v36, v40
    v_permlane32_swap_b32 v37, v41
    v_permlane32_swap_b32 v38, v42
    v_permlane32_swap_b32 v39, v43
    v_add_f32 v36, v36, v40
    v_add_f32 v37, v37, v41
    v_add_f32 v38, v38, v42
    v_add_f32 v39, v39, v43
    s_nop 0
    v_permlane16_swap_b32 v36, v38
    v_permlane16_swap_b32 v37, v39
    v_add_f32 v36, v36, v38
    v_add_f32 v37, v37, v39
    s_nop 0
    v_add_f32_dpp v36, v36, v36 row_ror:8 row_mask:0xf bank_mask:0x3
    s_nop 1
    v_add_f32_dpp v36, v37, v37 row_ror:8 row_mask:0xf bank_mask:0xc
    s_nop 1
    v_add_f32_dpp v36, v36, v36 row_shl:4 row_mask:0xf bank_mask:0x5
    v_cvt_pk_bf16_f32 v37, v36, v36
    v_and_b32 v37, 0xffff0000, v37
    v_sub_f32 v38, v36, v37
    v_cvt_pk_bf16_f32 v36, v37, v38
    v_bfe_u32 v5, v0, 3, 2
    v_bfe_u32 v6, v0, 5, 1
    v_lshl_add_u32 v5, v6, 3, v5
    v_and_b32 v6, 1, v0
    v_lshl_add_u32 v5, v6, 2, v5
    v_lshlrev_b32 v5, 4, v5
    v_bfe_u32 v6, v0, 1, 1
    v_lshl_add_u32 v5, v6, 10, v5
    s_mul_i32 s12, s16, 3
    s_add_u32 s12, s12, s19
    s_lshl_b32 s14, s12, 11
    s_lshl_b32 s15, s17, 8
    s_add_u32 s14, s14, s15
    s_lshr_b32 s15, s5, 3
    s_lshl_b32 s15, s15, 9
    s_add_u32 s14, s14, s15
    s_and_b32 s15, s5, 6
    s_lshl_b32 s15, s15, 1
    s_add_u32 s14, s14, s15
    s_add_u32 s14, s14, 131072
    s_cmp_ge_u32 s12, 43
    s_cselect_b32 s14, 0x7fff0000, s14
    s_cmp_eq_u32 s19, 3
    s_cselect_b32 s14, 0x7fff0000, s14
    s_mov_b32 exec_lo, 0x0f0f0f0f
    s_mov_b32 exec_hi, 0x0f0f0f0f
    buffer_store_dword v36, v5, s[40:43], s14 offen sc1
    s_mov_b64 exec, -1
    s_cmp_ge_u32 s38, 86
    s_cbranch_scc1 F_idle
    s_barrier
    ds_read_b64_tr_b16 v[48:49], v172 offset:0
    ds_read_b64_tr_b16 v[50:51], v172 offset:256
    ds_read_b64_tr_b16 v[36:37], v177 offset:0
    ds_read_b64_tr_b16 v[38:39], v177 offset:768
    ds_read_b64_tr_b16 v[52:53], v172 offset:2048
    ds_read_b64_tr_b16 v[54:55], v172 offset:2304
    ds_read_b64_tr_b16 v[40:41], v178 offset:0
    ds_read_b64_tr_b16 v[42:43], v178 offset:768
    ds_read_b64_tr_b16 v[44:45], v179 offset:0
    ds_read_b64_tr_b16 v[46:47], v179 offset:768
    s_waitcnt lgkmcnt(0)
    v_mfma_f32_32x32x16_bf16 v[76:91], v[36:39], v[48:51], 0
    ds_read_b64_tr_b16 v[68:69], v172 offset:1024
    ds_read_b64_tr_b16 v[70:71], v172 offset:1280
    ds_read_b64_tr_b16 v[56:57], v177 offset:3072
    v_mfma_f32_32x32x16_bf16 v[92:107], v[36:39], v[52:55], 0
    ds_read_b64_tr_b16 v[58:59], v177 offset:3840
    ds_read_b64_tr_b16 v[72:73], v172 offset:3072
    ds_read_b64_tr_b16 v[74:75], v172 offset:3328
    v_mfma_f32_32x32x16_bf16 v[108:123], v[40:43], v[48:51], 0
    ds_read_b64_tr_b16 v[60:61], v178 offset:3072
    ds_read_b64_tr_b16 v[62:63], v178 offset:3840
    ds_read_b64_tr_b16 v[64:65], v179 offset:3072
    v_mfma_f32_32x32x16_bf16 v[124:139], v[40:43], v[52:55], 0
    ds_read_b64_tr_b16 v[66:67], v179 offset:3840
    v_mfma_f32_32x32x16_bf16 v[140:155], v[44:47], v[48:51], 0
    v_mfma_f32_32x32x16_bf16 v[156:171], v[44:47], v[52:55], 0
    s_waitcnt lgkmcnt(0)
    s_barrier
    v_mfma_f32_32x32x16_bf16 v[76:91], v[56:59], v[68:71], v[76:91]
    ds_read_b64_tr_b16 v[48:49], v172 offset:8192
    ds_read_b64_tr_b16 v[50:51], v172 offset:8448
    ds_read_b64_tr_b16 v[36:37], v177 offset:12288
    v_mfma_f32_32x32x16_bf16 v[92:107], v[56:59], v[72:75], v[92:107]
    ds_read_b64_tr_b16 v[38:39], v177 offset:13056
    ds_read_b64_tr_b16 v[52:53], v172 offset:10240
    ds_read_b64_tr_b16 v[54:55], v172 offset:10496
    v_mfma_f32_32x32x16_bf16 v[108:123], v[60:63], v[68:71], v[108:123]
    ds_read_b64_tr_b16 v[40:41], v178 offset:12288
    ds_read_b64_tr_b16 v[42:43], v178 offset:13056
    ds_read_b64_tr_b16 v[44:45], v179 offset:12288
    v_mfma_f32_32x32x16_bf16 v[124:139], v[60:63], v[72:75], v[124:139]
    ds_read_b64_tr_b16 v[46:47], v179 offset:13056
    v_mfma_f32_32x32x16_bf16 v[140:155], v[64:67], v[68:71], v[140:155]
    v_mfma_f32_32x32x16_bf16 v[156:171], v[64:67], v[72:75], v[156:171]
    s_waitcnt lgkmcnt(0)
    v_mfma_f32_32x32x16_bf16 v[76:91], v[36:39], v[48:51], v[76:91]
    ds_read_b64_tr_b16 v[68:69], v172 offset:9216
    ds_read_b64_tr_b16 v[70:71], v172 offset:9472
    ds_read_b64_tr_b16 v[56:57], v177 offset:15360
    v_mfma_f32_32x32x16_bf16 v[92:107], v[36:39], v[52:55], v[92:107]
    ds_read_b64_tr_b16 v[58:59], v177 offset:16128
    ds_read_b64_tr_b16 v[72:73], v172 offset:11264
    ds_read_b64_tr_b16 v[74:75], v172 offset:11520
    v_mfma_f32_32x32x16_bf16 v[108:123], v[40:43], v[48:51], v[108:123]
    ds_read_b64_tr_b16 v[60:61], v178 offset:15360
    ds_read_b64_tr_b16 v[62:63], v178 offset:16128
    ds_read_b64_tr_b16 v[64:65], v179 offset:15360
    v_mfma_f32_32x32x16_bf16 v[124:139], v[40:43], v[52:55], v[124:139]
    ds_read_b64_tr_b16 v[66:67], v179 offset:16128
    v_mfma_f32_32x32x16_bf16 v[140:155], v[44:47], v[48:51], v[140:155]
    v_mfma_f32_32x32x16_bf16 v[156:171], v[44:47], v[52:55], v[156:171]
    buffer_store_dwordx4 v[244:247], v4, s[24:27], s52 offen sc1
    s_waitcnt lgkmcnt(0)
    s_barrier
    v_mfma_f32_32x32x16_bf16 v[76:91], v[56:59], v[68:71], v[76:91]
    ds_read_b64_tr_b16 v[48:49], v172 offset:16384
    ds_read_b64_tr_b16 v[50:51], v172 offset:16640
    ds_read_b64_tr_b16 v[36:37], v177 offset:24576
    v_mfma_f32_32x32x16_bf16 v[92:107], v[56:59], v[72:75], v[92:107]
    ds_read_b64_tr_b16 v[38:39], v177 offset:25344
    ds_read_b64_tr_b16 v[52:53], v172 offset:18432
    ds_read_b64_tr_b16 v[54:55], v172 offset:18688
    v_mfma_f32_32x32x16_bf16 v[108:123], v[60:63], v[68:71], v[108:123]
    ds_read_b64_tr_b16 v[40:41], v178 offset:24576
    ds_read_b64_tr_b16 v[42:43], v178 offset:25344
    ds_read_b64_tr_b16 v[44:45], v179 offset:24576
    v_mfma_f32_32x32x16_bf16 v[124:139], v[60:63], v[72:75], v[124:139]
    ds_read_b64_tr_b16 v[46:47], v179 offset:25344
    v_mfma_f32_32x32x16_bf16 v[140:155], v[64:67], v[68:71], v[140:155]
    v_mfma_f32_32x32x16_bf16 v[156:171], v[64:67], v[72:75], v[156:171]
    s_waitcnt lgkmcnt(0)
    v_mfma_f32_32x32x16_bf16 v[76:91], v[36:39], v[48:51], v[76:91]
    ds_read_b64_tr_b16 v[68:69], v172 offset:17408
    ds_read_b64_tr_b16 v[70:71], v172 offset:17664
    ds_read_b64_tr_b16 v[56:57], v177 offset:27648
    v_mfma_f32_32x32x16_bf16 v[92:107], v[36:39], v[52:55], v[92:107]
    ds_read_b64_tr_b16 v[58:59], v177 offset:28416
    ds_read_b64_tr_b16 v[72:73], v172 offset:19456
    ds_read_b64_tr_b16 v[74:75], v172 offset:19712
    v_mfma_f32_32x32x16_bf16 v[108:123], v[40:43], v[48:51], v[108:123]
    ds_read_b64_tr_b16 v[60:61], v178 offset:27648
    ds_read_b64_tr_b16 v[62:63], v178 offset:28416
    ds_read_b64_tr_b16 v[64:65], v179 offset:27648
    v_mfma_f32_32x32x16_bf16 v[124:139], v[40:43], v[52:55], v[124:139]
    ds_read_b64_tr_b16 v[66:67], v179 offset:28416
    v_mfma_f32_32x32x16_bf16 v[140:155], v[44:47], v[48:51], v[140:155]
    v_mfma_f32_32x32x16_bf16 v[156:171], v[44:47], v[52:55], v[156:171]
    s_waitcnt lgkmcnt(0)
    s_barrier
    v_mfma_f32_32x32x16_bf16 v[76:91], v[56:59], v[68:71], v[76:91]
    ds_read_b64_tr_b16 v[48:49], v172 offset:24576
    ds_read_b64_tr_b16 v[50:51], v172 offset:24832
    ds_read_b64_tr_b16 v[36:37], v177 offset:36864
    v_mfma_f32_32x32x16_bf16 v[92:107], v[56:59], v[72:75], v[92:107]
    ds_read_b64_tr_b16 v[38:39], v177 offset:37632
    ds_read_b64_tr_b16 v[52:53], v172 offset:26624
    ds_read_b64_tr_b16 v[54:55], v172 offset:26880
    v_mfma_f32_32x32x16_bf16 v[108:123], v[60:63], v[68:71], v[108:123]
    ds_read_b64_tr_b16 v[40:41], v178 offset:36864
    ds_read_b64_tr_b16 v[42:43], v178 offset:37632
    ds_read_b64_tr_b16 v[44:45], v179 offset:36864
    v_mfma_f32_32x32x16_bf16 v[124:139], v[60:63], v[72:75], v[124:139]
    ds_read_b64_tr_b16 v[46:47], v179 offset:37632
    v_mfma_f32_32x32x16_bf16 v[140:155], v[64:67], v[68:71], v[140:155]
    v_mfma_f32_32x32x16_bf16 v[156:171], v[64:67], v[72:75], v[156:171]
    s_waitcnt lgkmcnt(0)
    v_mfma_f32_32x32x16_bf16 v[76:91], v[36:39], v[48:51], v[76:91]
    ds_read_b64_tr_b16 v[68:69], v172 offset:25600
    ds_read_b64_tr_b16 v[70:71], v172 offset:25856
    ds_read_b64_tr_b16 v[56:57], v177 offset:39936
    v_mfma_f32_32x32x16_bf16 v[92:107], v[36:39], v[52:55], v[92:107]
    ds_read_b64_tr_b16 v[58:59], v177 offset:40704
    ds_read_b64_tr_b16 v[72:73], v172 offset:27648
    ds_read_b64_tr_b16 v[74:75], v172 offset:27904
    v_mfma_f32_32x32x16_bf16 v[108:123], v[40:43], v[48:51], v[108:123]
    ds_read_b64_tr_b16 v[60:61], v178 offset:39936
    ds_read_b64_tr_b16 v[62:63], v178 offset:40704
    ds_read_b64_tr_b16 v[64:65], v179 offset:39936
    v_mfma_f32_32x32x16_bf16 v[124:139], v[40:43], v[52:55], v[124:139]
    ds_read_b64_tr_b16 v[66:67], v179 offset:40704
    v_mfma_f32_32x32x16_bf16 v[140:155], v[44:47], v[48:51], v[140:155]
    v_mfma_f32_32x32x16_bf16 v[156:171], v[44:47], v[52:55], v[156:171]
    s_waitcnt lgkmcnt(0)
    s_barrier
    v_mfma_f32_32x32x16_bf16 v[76:91], v[56:59], v[68:71], v[76:91]
    ds_read_b64_tr_b16 v[48:49], v172 offset:32768
    ds_read_b64_tr_b16 v[50:51], v172 offset:33024
    ds_read_b64_tr_b16 v[36:37], v177 offset:49152
    v_mfma_f32_32x32x16_bf16 v[92:107], v[56:59], v[72:75], v[92:107]
    ds_read_b64_tr_b16 v[38:39], v177 offset:49920
    ds_read_b64_tr_b16 v[52:53], v172 offset:34816
    ds_read_b64_tr_b16 v[54:55], v172 offset:35072
    v_mfma_f32_32x32x16_bf16 v[108:123], v[60:63], v[68:71], v[108:123]
    ds_read_b64_tr_b16 v[40:41], v178 offset:49152
    ds_read_b64_tr_b16 v[42:43], v178 offset:49920
    ds_read_b64_tr_b16 v[44:45], v179 offset:49152
    v_mfma_f32_32x32x16_bf16 v[124:139], v[60:63], v[72:75], v[124:139]
    ds_read_b64_tr_b16 v[46:47], v179 offset:49920
    v_mfma_f32_32x32x16_bf16 v[140:155], v[64:67], v[68:71], v[140:155]
    v_mfma_f32_32x32x16_bf16 v[156:171], v[64:67], v[72:75], v[156:171]
    s_waitcnt lgkmcnt(0)
    v_mfma_f32_32x32x16_bf16 v[76:91], v[36:39], v[48:51], v[76:91]
    ds_read_b64_tr_b16 v[68:69], v172 offset:33792
    ds_read_b64_tr_b16 v[70:71], v172 offset:34048
    ds_read_b64_tr_b16 v[56:57], v177 offset:52224
    v_mfma_f32_32x32x16_bf16 v[92:107], v[36:39], v[52:55], v[92:107]
    ds_read_b64_tr_b16 v[58:59], v177 offset:52992
    ds_read_b64_tr_b16 v[72:73], v172 offset:35840
    ds_read_b64_tr_b16 v[74:75], v172 offset:36096
    v_mfma_f32_32x32x16_bf16 v[108:123], v[40:43], v[48:51], v[108:123]
    ds_read_b64_tr_b16 v[60:61], v178 offset:52224
    ds_read_b64_tr_b16 v[62:63], v178 offset:52992
    ds_read_b64_tr_b16 v[64:65], v179 offset:52224
    v_mfma_f32_32x32x16_bf16 v[124:139], v[40:43], v[52:55], v[124:139]
    ds_read_b64_tr_b16 v[66:67], v179 offset:52992
    v_mfma_f32_32x32x16_bf16 v[140:155], v[44:47], v[48:51], v[140:155]
    v_mfma_f32_32x32x16_bf16 v[156:171], v[44:47], v[52:55], v[156:171]
    buffer_store_dwordx4 v[244:247], v4, s[24:27], s53 offen sc1
    s_waitcnt lgkmcnt(0)
    s_barrier
    v_mfma_f32_32x32x16_bf16 v[76:91], v[56:59], v[68:71], v[76:91]
    ds_read_b64_tr_b16 v[48:49], v172 offset:40960
    ds_read_b64_tr_b16 v[50:51], v172 offset:41216
    ds_read_b64_tr_b16 v[36:37], v174 offset:0
    v_mfma_f32_32x32x16_bf16 v[92:107], v[56:59], v[72:75], v[92:107]
    ds_read_b64_tr_b16 v[38:39], v174 offset:768
    ds_read_b64_tr_b16 v[52:53], v172 offset:43008
    ds_read_b64_tr_b16 v[54:55], v172 offset:43264
    v_mfma_f32_32x32x16_bf16 v[108:123], v[60:63], v[68:71], v[108:123]
    ds_read_b64_tr_b16 v[40:41], v175 offset:0
    ds_read_b64_tr_b16 v[42:43], v175 offset:768
    ds_read_b64_tr_b16 v[44:45], v176 offset:0
    v_mfma_f32_32x32x16_bf16 v[124:139], v[60:63], v[72:75], v[124:139]
    ds_read_b64_tr_b16 v[46:47], v176 offset:768
    v_mfma_f32_32x32x16_bf16 v[140:155], v[64:67], v[68:71], v[140:155]
    v_mfma_f32_32x32x16_bf16 v[156:171], v[64:67], v[72:75], v[156:171]
    s_waitcnt lgkmcnt(0)
    v_mfma_f32_32x32x16_bf16 v[76:91], v[36:39], v[48:51], v[76:91]
    ds_read_b64_tr_b16 v[68:69], v172 offset:41984
    ds_read_b64_tr_b16 v[70:71], v172 offset:42240
    ds_read_b64_tr_b16 v[56:57], v174 offset:3072
    v_mfma_f32_32x32x16_bf16 v[92:107], v[36:39], v[52:55], v[92:107]
    ds_read_b64_tr_b16 v[58:59], v174 offset:3840
    ds_read_b64_tr_b16 v[72:73], v172 offset:44032
    ds_read_b64_tr_b16 v[74:75], v172 offset:44288
    v_mfma_f32_32x32x16_bf16 v[108:123], v[40:43], v[48:51], v[108:123]
    ds_read_b64_tr_b16 v[60:61], v175 offset:3072
    ds_read_b64_tr_b16 v[62:63], v175 offset:3840
    ds_read_b64_tr_b16 v[64:65], v176 offset:3072
    v_mfma_f32_32x32x16_bf16 v[124:139], v[40:43], v[52:55], v[124:139]
    ds_read_b64_tr_b16 v[66:67], v176 offset:3840
    v_mfma_f32_32x32x16_bf16 v[140:155], v[44:47], v[48:51], v[140:155]
    v_mfma_f32_32x32x16_bf16 v[156:171], v[44:47], v[52:55], v[156:171]
    s_waitcnt lgkmcnt(0)
    s_barrier
    v_mfma_f32_32x32x16_bf16 v[76:91], v[56:59], v[68:71], v[76:91]
    ds_read_b64_tr_b16 v[48:49], v172 offset:49152
    ds_read_b64_tr_b16 v[50:51], v172 offset:49408
    ds_read_b64_tr_b16 v[36:37], v174 offset:12288
    v_mfma_f32_32x32x16_bf16 v[92:107], v[56:59], v[72:75], v[92:107]
    ds_read_b64_tr_b16 v[38:39], v174 offset:13056
    ds_read_b64_tr_b16 v[52:53], v172 offset:51200
    ds_read_b64_tr_b16 v[54:55], v172 offset:51456
    v_mfma_f32_32x32x16_bf16 v[108:123], v[60:63], v[68:71], v[108:123]
    ds_read_b64_tr_b16 v[40:41], v175 offset:12288
    ds_read_b64_tr_b16 v[42:43], v175 offset:13056
    ds_read_b64_tr_b16 v[44:45], v176 offset:12288
    v_mfma_f32_32x32x16_bf16 v[124:139], v[60:63], v[72:75], v[124:139]
    ds_read_b64_tr_b16 v[46:47], v176 offset:13056
    v_mfma_f32_32x32x16_bf16 v[140:155], v[64:67], v[68:71], v[140:155]
    v_mfma_f32_32x32x16_bf16 v[156:171], v[64:67], v[72:75], v[156:171]
    s_waitcnt lgkmcnt(0)
    v_mfma_f32_32x32x16_bf16 v[76:91], v[36:39], v[48:51], v[76:91]
    ds_read_b64_tr_b16 v[68:69], v172 offset:50176
    ds_read_b64_tr_b16 v[70:71], v172 offset:50432
    ds_read_b64_tr_b16 v[56:57], v174 offset:15360
    v_mfma_f32_32x32x16_bf16 v[92:107], v[36:39], v[52:55], v[92:107]
    ds_read_b64_tr_b16 v[58:59], v174 offset:16128
    ds_read_b64_tr_b16 v[72:73], v172 offset:52224
    ds_read_b64_tr_b16 v[74:75], v172 offset:52480
    v_mfma_f32_32x32x16_bf16 v[108:123], v[40:43], v[48:51], v[108:123]
    ds_read_b64_tr_b16 v[60:61], v175 offset:15360
    ds_read_b64_tr_b16 v[62:63], v175 offset:16128
    ds_read_b64_tr_b16 v[64:65], v176 offset:15360
    v_mfma_f32_32x32x16_bf16 v[124:139], v[40:43], v[52:55], v[124:139]
    ds_read_b64_tr_b16 v[66:67], v176 offset:16128
    v_mfma_f32_32x32x16_bf16 v[140:155], v[44:47], v[48:51], v[140:155]
    v_mfma_f32_32x32x16_bf16 v[156:171], v[44:47], v[52:55], v[156:171]
    s_waitcnt lgkmcnt(0)
    s_barrier
    v_mfma_f32_32x32x16_bf16 v[76:91], v[56:59], v[68:71], v[76:91]
    ds_read_b64_tr_b16 v[48:49], v172 offset:57344
    ds_read_b64_tr_b16 v[50:51], v172 offset:57600
    ds_read_b64_tr_b16 v[36:37], v174 offset:24576
    v_mfma_f32_32x32x16_bf16 v[92:107], v[56:59], v[72:75], v[92:107]
    ds_read_b64_tr_b16 v[38:39], v174 offset:25344
    ds_read_b64_tr_b16 v[52:53], v172 offset:59392
    ds_read_b64_tr_b16 v[54:55], v172 offset:59648
    v_mfma_f32_32x32x16_bf16 v[108:123], v[60:63], v[68:71], v[108:123]
    ds_read_b64_tr_b16 v[40:41], v175 offset:24576
    ds_read_b64_tr_b16 v[42:43], v175 offset:25344
    ds_read_b64_tr_b16 v[44:45], v176 offset:24576
    v_mfma_f32_32x32x16_bf16 v[124:139], v[60:63], v[72:75], v[124:139]
    ds_read_b64_tr_b16 v[46:47], v176 offset:25344
    v_mfma_f32_32x32x16_bf16 v[140:155], v[64:67], v[68:71], v[140:155]
    v_mfma_f32_32x32x16_bf16 v[156:171], v[64:67], v[72:75], v[156:171]
    s_waitcnt lgkmcnt(0)
    v_mfma_f32_32x32x16_bf16 v[76:91], v[36:39], v[48:51], v[76:91]
    ds_read_b64_tr_b16 v[68:69], v172 offset:58368
    ds_read_b64_tr_b16 v[70:71], v172 offset:58624
    ds_read_b64_tr_b16 v[56:57], v174 offset:27648
    v_mfma_f32_32x32x16_bf16 v[92:107], v[36:39], v[52:55], v[92:107]
    ds_read_b64_tr_b16 v[58:59], v174 offset:28416
    ds_read_b64_tr_b16 v[72:73], v172 offset:60416
    ds_read_b64_tr_b16 v[74:75], v172 offset:60672
    v_mfma_f32_32x32x16_bf16 v[108:123], v[40:43], v[48:51], v[108:123]
    ds_read_b64_tr_b16 v[60:61], v175 offset:27648
    ds_read_b64_tr_b16 v[62:63], v175 offset:28416
    ds_read_b64_tr_b16 v[64:65], v176 offset:27648
    v_mfma_f32_32x32x16_bf16 v[124:139], v[40:43], v[52:55], v[124:139]
    ds_read_b64_tr_b16 v[66:67], v176 offset:28416
    v_mfma_f32_32x32x16_bf16 v[140:155], v[44:47], v[48:51], v[140:155]
    buffer_load_dwordx4 v[20:23], v2, s[32:35], s36 offen offset:0 sc1
    v_mfma_f32_32x32x16_bf16 v[156:171], v[44:47], v[52:55], v[156:171]
    buffer_store_dwordx4 v[244:247], v4, s[24:27], s54 offen sc1
    s_waitcnt lgkmcnt(0)
    s_barrier
    v_mfma_f32_32x32x16_bf16 v[76:91], v[56:59], v[68:71], v[76:91]
    ds_read_b64_tr_b16 v[48:49], v172 offset:0
    ds_read_b64_tr_b16 v[50:51], v172 offset:256
    ds_read_b64_tr_b16 v[36:37], v177 offset:0
    v_mfma_f32_32x32x16_bf16 v[92:107], v[56:59], v[72:75], v[92:107]
    ds_read_b64_tr_b16 v[38:39], v177 offset:768
    ds_read_b64_tr_b16 v[52:53], v172 offset:2048
    ds_read_b64_tr_b16 v[54:55], v172 offset:2304
    v_mfma_f32_32x32x16_bf16 v[108:123], v[60:63], v[68:71], v[108:123]
    ds_read_b64_tr_b16 v[40:41], v178 offset:0
    ds_read_b64_tr_b16 v[42:43], v178 offset:768
    ds_read_b64_tr_b16 v[44:45], v179 offset:0
    v_mfma_f32_32x32x16_bf16 v[124:139], v[60:63], v[72:75], v[124:139]
    ds_read_b64_tr_b16 v[46:47], v179 offset:768
    v_mfma_f32_32x32x16_bf16 v[140:155], v[64:67], v[68:71], v[140:155]
    buffer_load_dwordx4 v[24:27], v2, s[32:35], s36 offen offset:1024 sc1
    v_mfma_f32_32x32x16_bf16 v[156:171], v[64:67], v[72:75], v[156:171]
    s_waitcnt lgkmcnt(0)
    v_mfma_f32_32x32x16_bf16 v[76:91], v[36:39], v[48:51], v[76:91]
    ds_read_b64_tr_b16 v[68:69], v172 offset:1024
    ds_read_b64_tr_b16 v[70:71], v172 offset:1280
    ds_read_b64_tr_b16 v[56:57], v177 offset:3072
    v_mfma_f32_32x32x16_bf16 v[92:107], v[36:39], v[52:55], v[92:107]
    ds_read_b64_tr_b16 v[58:59], v177 offset:3840
    ds_read_b64_tr_b16 v[72:73], v172 offset:3072
    ds_read_b64_tr_b16 v[74:75], v172 offset:3328
    v_mfma_f32_32x32x16_bf16 v[108:123], v[40:43], v[48:51], v[108:123]
    ds_read_b64_tr_b16 v[60:61], v178 offset:3072
    ds_read_b64_tr_b16 v[62:63], v178 offset:3840
    ds_read_b64_tr_b16 v[64:65], v179 offset:3072
    v_mfma_f32_32x32x16_bf16 v[124:139], v[40:43], v[52:55], v[124:139]
    ds_read_b64_tr_b16 v[66:67], v179 offset:3840
    v_mfma_f32_32x32x16_bf16 v[140:155], v[44:47], v[48:51], v[140:155]
    buffer_load_dwordx4 v[28:31], v2, s[32:35], s36 offen offset:2048 sc1
    v_mfma_f32_32x32x16_bf16 v[156:171], v[44:47], v[52:55], v[156:171]
    s_waitcnt lgkmcnt(0)
    s_barrier
    v_mfma_f32_32x32x16_bf16 v[76:91], v[56:59], v[68:71], v[76:91]
    ds_read_b64_tr_b16 v[48:49], v172 offset:8192
    ds_read_b64_tr_b16 v[50:51], v172 offset:8448
    ds_read_b64_tr_b16 v[36:37], v177 offset:12288
    v_mfma_f32_32x32x16_bf16 v[92:107], v[56:59], v[72:75], v[92:107]
    ds_read_b64_tr_b16 v[38:39], v177 offset:13056
    ds_read_b64_tr_b16 v[52:53], v172 offset:10240
    ds_read_b64_tr_b16 v[54:55], v172 offset:10496
    v_mfma_f32_32x32x16_bf16 v[108:123], v[60:63], v[68:71], v[108:123]
    ds_read_b64_tr_b16 v[40:41], v178 offset:12288
    ds_read_b64_tr_b16 v[42:43], v178 offset:13056
    ds_read_b64_tr_b16 v[44:45], v179 offset:12288
    v_mfma_f32_32x32x16_bf16 v[124:139], v[60:63], v[72:75], v[124:139]
    ds_read_b64_tr_b16 v[46:47], v179 offset:13056
    v_mfma_f32_32x32x16_bf16 v[140:155], v[64:67], v[68:71], v[140:155]
    v_mfma_f32_32x32x16_bf16 v[156:171], v[64:67], v[72:75], v[156:171]
    s_waitcnt lgkmcnt(0)
    v_mfma_f32_32x32x16_bf16 v[76:91], v[36:39], v[48:51], v[76:91]
    ds_read_b64_tr_b16 v[68:69], v172 offset:9216
    ds_read_b64_tr_b16 v[70:71], v172 offset:9472
    ds_read_b64_tr_b16 v[56:57], v177 offset:15360
    v_mfma_f32_32x32x16_bf16 v[92:107], v[36:39], v[52:55], v[92:107]
    ds_read_b64_tr_b16 v[58:59], v177 offset:16128
    ds_read_b64_tr_b16 v[72:73], v172 offset:11264
    ds_read_b64_tr_b16 v[74:75], v172 offset:11520
    v_mfma_f32_32x32x16_bf16 v[108:123], v[40:43], v[48:51], v[108:123]
    ds_read_b64_tr_b16 v[60:61], v178 offset:15360
    ds_read_b64_tr_b16 v[62:63], v178 offset:16128
    ds_read_b64_tr_b16 v[64:65], v179 offset:15360
    v_mfma_f32_32x32x16_bf16 v[124:139], v[40:43], v[52:55], v[124:139]
    ds_read_b64_tr_b16 v[66:67], v179 offset:16128
    v_mfma_f32_32x32x16_bf16 v[140:155], v[44:47], v[48:51], v[140:155]
    v_mfma_f32_32x32x16_bf16 v[156:171], v[44:47], v[52:55], v[156:171]
    s_waitcnt lgkmcnt(0)
    s_barrier
    v_mfma_f32_32x32x16_bf16 v[76:91], v[56:59], v[68:71], v[76:91]
    ds_read_b64_tr_b16 v[48:49], v172 offset:16384
    ds_read_b64_tr_b16 v[50:51], v172 offset:16640
    ds_read_b64_tr_b16 v[36:37], v177 offset:24576
    v_mfma_f32_32x32x16_bf16 v[92:107], v[56:59], v[72:75], v[92:107]
    ds_read_b64_tr_b16 v[38:39], v177 offset:25344
    ds_read_b64_tr_b16 v[52:53], v172 offset:18432
    ds_read_b64_tr_b16 v[54:55], v172 offset:18688
    v_mfma_f32_32x32x16_bf16 v[108:123], v[60:63], v[68:71], v[108:123]
    ds_read_b64_tr_b16 v[40:41], v178 offset:24576
    ds_read_b64_tr_b16 v[42:43], v178 offset:25344
    ds_read_b64_tr_b16 v[44:45], v179 offset:24576
    v_mfma_f32_32x32x16_bf16 v[124:139], v[60:63], v[72:75], v[124:139]
    ds_read_b64_tr_b16 v[46:47], v179 offset:25344
    v_mfma_f32_32x32x16_bf16 v[140:155], v[64:67], v[68:71], v[140:155]
    v_mfma_f32_32x32x16_bf16 v[156:171], v[64:67], v[72:75], v[156:171]
    s_waitcnt lgkmcnt(0)
    v_mfma_f32_32x32x16_bf16 v[76:91], v[36:39], v[48:51], v[76:91]
    ds_read_b64_tr_b16 v[68:69], v172 offset:17408
    ds_read_b64_tr_b16 v[70:71], v172 offset:17664
    ds_read_b64_tr_b16 v[56:57], v177 offset:27648
    v_mfma_f32_32x32x16_bf16 v[92:107], v[36:39], v[52:55], v[92:107]
    ds_read_b64_tr_b16 v[58:59], v177 offset:28416
    ds_read_b64_tr_b16 v[72:73], v172 offset:19456
    ds_read_b64_tr_b16 v[74:75], v172 offset:19712
    v_mfma_f32_32x32x16_bf16 v[108:123], v[40:43], v[48:51], v[108:123]
    ds_read_b64_tr_b16 v[60:61], v178 offset:27648
    ds_read_b64_tr_b16 v[62:63], v178 offset:28416
    ds_read_b64_tr_b16 v[64:65], v179 offset:27648
    v_mfma_f32_32x32x16_bf16 v[124:139], v[40:43], v[52:55], v[124:139]
    ds_read_b64_tr_b16 v[66:67], v179 offset:28416
    v_mfma_f32_32x32x16_bf16 v[140:155], v[44:47], v[48:51], v[140:155]
    v_mfma_f32_32x32x16_bf16 v[156:171], v[44:47], v[52:55], v[156:171]
    buffer_store_dwordx4 v[244:247], v4, s[24:27], s55 offen sc1
    s_waitcnt lgkmcnt(0)
    s_barrier
    v_mfma_f32_32x32x16_bf16 v[76:91], v[56:59], v[68:71], v[76:91]
    ds_read_b64_tr_b16 v[48:49], v172 offset:24576
    ds_read_b64_tr_b16 v[50:51], v172 offset:24832
    ds_read_b64_tr_b16 v[36:37], v177 offset:36864
    v_mfma_f32_32x32x16_bf16 v[92:107], v[56:59], v[72:75], v[92:107]
    ds_read_b64_tr_b16 v[38:39], v177 offset:37632
    ds_read_b64_tr_b16 v[52:53], v172 offset:26624
    ds_read_b64_tr_b16 v[54:55], v172 offset:26880
    v_mfma_f32_32x32x16_bf16 v[108:123], v[60:63], v[68:71], v[108:123]
    ds_read_b64_tr_b16 v[40:41], v178 offset:36864
    ds_read_b64_tr_b16 v[42:43], v178 offset:37632
    ds_read_b64_tr_b16 v[44:45], v179 offset:36864
    v_mfma_f32_32x32x16_bf16 v[124:139], v[60:63], v[72:75], v[124:139]
    ds_read_b64_tr_b16 v[46:47], v179 offset:37632
    v_mfma_f32_32x32x16_bf16 v[140:155], v[64:67], v[68:71], v[140:155]
    v_mfma_f32_32x32x16_bf16 v[156:171], v[64:67], v[72:75], v[156:171]
    s_waitcnt lgkmcnt(0)
    v_mfma_f32_32x32x16_bf16 v[76:91], v[36:39], v[48:51], v[76:91]
    ds_read_b64_tr_b16 v[68:69], v172 offset:25600
    ds_read_b64_tr_b16 v[70:71], v172 offset:25856
    ds_read_b64_tr_b16 v[56:57], v177 offset:39936
    v_mfma_f32_32x32x16_bf16 v[92:107], v[36:39], v[52:55], v[92:107]
    ds_read_b64_tr_b16 v[58:59], v177 offset:40704
    ds_read_b64_tr_b16 v[72:73], v172 offset:27648
    ds_read_b64_tr_b16 v[74:75], v172 offset:27904
    v_mfma_f32_32x32x16_bf16 v[108:123], v[40:43], v[48:51], v[108:123]
    ds_read_b64_tr_b16 v[60:61], v178 offset:39936
    ds_read_b64_tr_b16 v[62:63], v178 offset:40704
    ds_read_b64_tr_b16 v[64:65], v179 offset:39936
    v_mfma_f32_32x32x16_bf16 v[124:139], v[40:43], v[52:55], v[124:139]
    ds_read_b64_tr_b16 v[66:67], v179 offset:40704
    v_mfma_f32_32x32x16_bf16 v[140:155], v[44:47], v[48:51], v[140:155]
    v_mfma_f32_32x32x16_bf16 v[156:171], v[44:47], v[52:55], v[156:171]
    s_waitcnt lgkmcnt(0)
    s_barrier
    v_mfma_f32_32x32x16_bf16 v[76:91], v[56:59], v[68:71], v[76:91]
    ds_read_b64_tr_b16 v[48:49], v172 offset:32768
    ds_read_b64_tr_b16 v[50:51], v172 offset:33024
    ds_read_b64_tr_b16 v[36:37], v177 offset:49152
    v_mfma_f32_32x32x16_bf16 v[92:107], v[56:59], v[72:75], v[92:107]
    ds_read_b64_tr_b16 v[38:39], v177 offset:49920
    ds_read_b64_tr_b16 v[52:53], v172 offset:34816
    ds_read_b64_tr_b16 v[54:55], v172 offset:35072
    v_mfma_f32_32x32x16_bf16 v[108:123], v[60:63], v[68:71], v[108:123]
    ds_read_b64_tr_b16 v[40:41], v178 offset:49152
    ds_read_b64_tr_b16 v[42:43], v178 offset:49920
    ds_read_b64_tr_b16 v[44:45], v179 offset:49152
    v_mfma_f32_32x32x16_bf16 v[124:139], v[60:63], v[72:75], v[124:139]
    ds_read_b64_tr_b16 v[46:47], v179 offset:49920
    v_mfma_f32_32x32x16_bf16 v[140:155], v[64:67], v[68:71], v[140:155]
    v_mfma_f32_32x32x16_bf16 v[156:171], v[64:67], v[72:75], v[156:171]
    s_waitcnt lgkmcnt(0)
    v_mfma_f32_32x32x16_bf16 v[76:91], v[36:39], v[48:51], v[76:91]
    ds_read_b64_tr_b16 v[68:69], v172 offset:33792
    ds_read_b64_tr_b16 v[70:71], v172 offset:34048
    ds_read_b64_tr_b16 v[56:57], v177 offset:52224
    v_mfma_f32_32x32x16_bf16 v[92:107], v[36:39], v[52:55], v[92:107]
    ds_read_b64_tr_b16 v[58:59], v177 offset:52992
    ds_read_b64_tr_b16 v[72:73], v172 offset:35840
    ds_read_b64_tr_b16 v[74:75], v172 offset:36096
    v_mfma_f32_32x32x16_bf16 v[108:123], v[40:43], v[48:51], v[108:123]
    ds_read_b64_tr_b16 v[60:61], v178 offset:52224
    ds_read_b64_tr_b16 v[62:63], v178 offset:52992
    ds_read_b64_tr_b16 v[64:65], v179 offset:52224
    v_mfma_f32_32x32x16_bf16 v[124:139], v[40:43], v[52:55], v[124:139]
    ds_read_b64_tr_b16 v[66:67], v179 offset:52992
    v_mfma_f32_32x32x16_bf16 v[140:155], v[44:47], v[48:51], v[140:155]
    v_mfma_f32_32x32x16_bf16 v[156:171], v[44:47], v[52:55], v[156:171]
    s_waitcnt lgkmcnt(0)
    s_barrier
    v_mfma_f32_32x32x16_bf16 v[76:91], v[56:59], v[68:71], v[76:91]
    ds_read_b64_tr_b16 v[48:49], v172 offset:40960
    ds_read_b64_tr_b16 v[50:51], v172 offset:41216
    ds_read_b64_tr_b16 v[36:37], v174 offset:0
    v_mfma_f32_32x32x16_bf16 v[92:107], v[56:59], v[72:75], v[92:107]
    ds_read_b64_tr_b16 v[38:39], v174 offset:768
    ds_read_b64_tr_b16 v[52:53], v172 offset:43008
    ds_read_b64_tr_b16 v[54:55], v172 offset:43264
    v_mfma_f32_32x32x16_bf16 v[108:123], v[60:63], v[68:71], v[108:123]
    ds_read_b64_tr_b16 v[40:41], v175 offset:0
    ds_read_b64_tr_b16 v[42:43], v175 offset:768
    ds_read_b64_tr_b16 v[44:45], v176 offset:0
    v_mfma_f32_32x32x16_bf16 v[124:139], v[60:63], v[72:75], v[124:139]
    ds_read_b64_tr_b16 v[46:47], v176 offset:768
    s_waitcnt vmcnt(0)
    v_max3_u32 v32, v20, v21, v22
    v_mfma_f32_32x32x16_bf16 v[140:155], v[64:67], v[68:71], v[140:155]
    v_max3_u32 v32, v32, v23, v24
    v_max3_u32 v32, v32, v25, v26
    v_max3_u32 v32, v32, v27, v28
    v_mfma_f32_32x32x16_bf16 v[156:171], v[64:67], v[72:75], v[156:171]
    v_max3_u32 v32, v32, v29, v30
    v_max3_u32 v32, v32, v31, v31
    s_waitcnt lgkmcnt(0)
    v_mfma_f32_32x32x16_bf16 v[76:91], v[36:39], v[48:51], v[76:91]
    ds_read_b64_tr_b16 v[68:69], v172 offset:41984
    ds_read_b64_tr_b16 v[70:71], v172 offset:42240
    ds_read_b64_tr_b16 v[56:57], v174 offset:3072
    v_mfma_f32_32x32x16_bf16 v[92:107], v[36:39], v[52:55], v[92:107]
    ds_read_b64_tr_b16 v[58:59], v174 offset:3840
    ds_read_b64_tr_b16 v[72:73], v172 offset:44032
    ds_read_b64_tr_b16 v[74:75], v172 offset:44288
    v_mfma_f32_32x32x16_bf16 v[108:123], v[40:43], v[48:51], v[108:123]
    ds_read_b64_tr_b16 v[60:61], v175 offset:3072
    ds_read_b64_tr_b16 v[62:63], v175 offset:3840
    ds_read_b64_tr_b16 v[64:65], v176 offset:3072
    v_mfma_f32_32x32x16_bf16 v[124:139], v[40:43], v[52:55], v[124:139]
    ds_read_b64_tr_b16 v[66:67], v176 offset:3840
    v_mfma_f32_32x32x16_bf16 v[140:155], v[44:47], v[48:51], v[140:155]
    buffer_load_dword v34, v18, s[40:43], s48 offen sc1
    v_mfma_f32_32x32x16_bf16 v[156:171], v[44:47], v[52:55], v[156:171]
    s_waitcnt lgkmcnt(0)
    s_barrier
    v_mfma_f32_32x32x16_bf16 v[76:91], v[56:59], v[68:71], v[76:91]
    ds_read_b64_tr_b16 v[48:49], v172 offset:49152
    ds_read_b64_tr_b16 v[50:51], v172 offset:49408
    ds_read_b64_tr_b16 v[36:37], v174 offset:12288
    v_mfma_f32_32x32x16_bf16 v[92:107], v[56:59], v[72:75], v[92:107]
    ds_read_b64_tr_b16 v[38:39], v174 offset:13056
    ds_read_b64_tr_b16 v[52:53], v172 offset:51200
    ds_read_b64_tr_b16 v[54:55], v172 offset:51456
    v_mfma_f32_32x32x16_bf16 v[108:123], v[60:63], v[68:71], v[108:123]
    ds_read_b64_tr_b16 v[40:41], v175 offset:12288
    ds_read_b64_tr_b16 v[42:43], v175 offset:13056
    ds_read_b64_tr_b16 v[44:45], v176 offset:12288
    v_mfma_f32_32x32x16_bf16 v[124:139], v[60:63], v[72:75], v[124:139]
    ds_read_b64_tr_b16 v[46:47], v176 offset:13056
    v_mfma_f32_32x32x16_bf16 v[140:155], v[64:67], v[68:71], v[140:155]
    buffer_load_dword v35, v18, s[40:43], s48 offen offset:128 sc1
    v_mfma_f32_32x32x16_bf16 v[156:171], v[64:67], v[72:75], v[156:171]
    s_waitcnt lgkmcnt(0)
    v_mfma_f32_32x32x16_bf16 v[76:91], v[36:39], v[48:51], v[76:91]
    ds_read_b64_tr_b16 v[68:69], v172 offset:50176
    ds_read_b64_tr_b16 v[70:71], v172 offset:50432
    ds_read_b64_tr_b16 v[56:57], v174 offset:15360
    v_mfma_f32_32x32x16_bf16 v[92:107], v[36:39], v[52:55], v[92:107]
    ds_read_b64_tr_b16 v[58:59], v174 offset:16128
    ds_read_b64_tr_b16 v[72:73], v172 offset:52224
    ds_read_b64_tr_b16 v[74:75], v172 offset:52480
    v_mfma_f32_32x32x16_bf16 v[108:123], v[40:43], v[48:51], v[108:123]
    ds_read_b64_tr_b16 v[60:61], v175 offset:15360
    ds_read_b64_tr_b16 v[62:63], v175 offset:16128
    ds_read_b64_tr_b16 v[64:65], v176 offset:15360
    v_mfma_f32_32x32x16_bf16 v[124:139], v[40:43], v[52:55], v[124:139]
    ds_read_b64_tr_b16 v[66:67], v176 offset:16128
    v_mfma_f32_32x32x16_bf16 v[140:155], v[44:47], v[48:51], v[140:155]
    v_mfma_f32_32x32x16_bf16 v[156:171], v[44:47], v[52:55], v[156:171]
    s_waitcnt lgkmcnt(0)
    s_barrier
    v_mfma_f32_32x32x16_bf16 v[76:91], v[56:59], v[68:71], v[76:91]
    ds_read_b64_tr_b16 v[48:49], v172 offset:57344
    ds_read_b64_tr_b16 v[50:51], v172 offset:57600
    ds_read_b64_tr_b16 v[36:37], v174 offset:24576
    v_mfma_f32_32x32x16_bf16 v[92:107], v[56:59], v[72:75], v[92:107]
    ds_read_b64_tr_b16 v[38:39], v174 offset:25344
    ds_read_b64_tr_b16 v[52:53], v172 offset:59392
    ds_read_b64_tr_b16 v[54:55], v172 offset:59648
    v_mfma_f32_32x32x16_bf16 v[108:123], v[60:63], v[68:71], v[108:123]
    ds_read_b64_tr_b16 v[40:41], v175 offset:24576
    ds_read_b64_tr_b16 v[42:43], v175 offset:25344
    ds_read_b64_tr_b16 v[44:45], v176 offset:24576
    v_mfma_f32_32x32x16_bf16 v[124:139], v[60:63], v[72:75], v[124:139]
    ds_read_b64_tr_b16 v[46:47], v176 offset:25344
    v_mfma_f32_32x32x16_bf16 v[140:155], v[64:67], v[68:71], v[140:155]
    v_mfma_f32_32x32x16_bf16 v[156:171], v[64:67], v[72:75], v[156:171]
    s_waitcnt lgkmcnt(0)
    v_mfma_f32_32x32x16_bf16 v[76:91], v[36:39], v[48:51], v[76:91]
    ds_read_b64_tr_b16 v[68:69], v172 offset:58368
    ds_read_b64_tr_b16 v[70:71], v172 offset:58624
    ds_read_b64_tr_b16 v[56:57], v174 offset:27648
    v_mfma_f32_32x32x16_bf16 v[92:107], v[36:39], v[52:55], v[92:107]
    ds_read_b64_tr_b16 v[58:59], v174 offset:28416
    ds_read_b64_tr_b16 v[72:73], v172 offset:60416
    ds_read_b64_tr_b16 v[74:75], v172 offset:60672
    v_mfma_f32_32x32x16_bf16 v[108:123], v[40:43], v[48:51], v[108:123]
    ds_read_b64_tr_b16 v[60:61], v175 offset:27648
    ds_read_b64_tr_b16 v[62:63], v175 offset:28416
    ds_read_b64_tr_b16 v[64:65], v176 offset:27648
    v_mfma_f32_32x32x16_bf16 v[124:139], v[40:43], v[52:55], v[124:139]
    ds_read_b64_tr_b16 v[66:67], v176 offset:28416
    v_mfma_f32_32x32x16_bf16 v[140:155], v[44:47], v[48:51], v[140:155]
    v_mfma_f32_32x32x16_bf16 v[156:171], v[44:47], v[52:55], v[156:171]
    s_waitcnt lgkmcnt(0)
    s_barrier
    v_mfma_f32_32x32x16_bf16 v[76:91], v[56:59], v[68:71], v[76:91]
    s_mov_b32 s37, 0x01000100
    s_waitcnt vmcnt(0)
    v_max3_u32 v19, v32, v34, v35
    v_cmp_eq_u32 vcc, -1, v19
    s_cbranch_vccnz F_spoll
F_sgot:
    v_mfma_f32_32x32x16_bf16 v[92:107], v[56:59], v[72:75], v[92:107]
    v_perm_b32 v36, v34, v34, s37
    v_perm_b32 v37, v34, v34, s37
    v_perm_b32 v38, v34, v34, s37
    v_mfma_f32_32x32x16_bf16 v[108:123], v[60:63], v[68:71], v[108:123]
    v_perm_b32 v39, v34, v34, s37
    v_perm_b32 v40, v35, v35, s37
    v_perm_b32 v41, v35, v35, s37
    v_mfma_f32_32x32x16_bf16 v[124:139], v[60:63], v[72:75], v[124:139]
    v_perm_b32 v42, v35, v35, s37
    v_perm_b32 v43, v35, v35, s37
    v_and_b32 v44, 0xffff0000, v34
    v_mfma_f32_32x32x16_bf16 v[140:155], v[64:67], v[68:71], v[140:155]
    v_and_b32 v46, 0xffff0000, v35
    v_rcp_f32 v48, v44
    v_rcp_f32 v50, v46
    v_mfma_f32_32x32x16_bf16 v[156:171], v[64:67], v[72:75], v[156:171]
    v_mul_f32 v48, 0xbfb8aa3b, v48
    v_mul_f32 v50, 0xbfb8aa3b, v50
    v_mfma_f32_32x32x16_bf16 v[76:91], v[20:23], v[36:39], v[76:91]
    v_mfma_f32_32x32x16_bf16 v[92:107], v[20:23], v[40:43], v[92:107]
    v_mfma_f32_32x32x16_bf16 v[108:123], v[24:27], v[36:39], v[108:123]
    v_mfma_f32_32x32x16_bf16 v[124:139], v[24:27], v[40:43], v[124:139]
    v_mfma_f32_32x32x16_bf16 v[140:155], v[28:31], v[36:39], v[140:155]
    v_mfma_f32_32x32x16_bf16 v[156:171], v[28:31], v[40:43], v[156:171]
    s_cmp_ge_u32 s38, 84
    s_cselect_b32 s10, 0x7fffffff, 0
    v_or_b32 v3, s10, v2
    s_nop 3
    v_pk_mul_f32 v[76:77], v[76:77], v[48:49] op_sel_hi:[1,0]
    v_pk_mul_f32 v[78:79], v[78:79], v[48:49] op_sel_hi:[1,0]
    v_pk_mul_f32 v[80:81], v[80:81], v[48:49] op_sel_hi:[1,0]
    v_pk_mul_f32 v[82:83], v[82:83], v[48:49] op_sel_hi:[1,0]
    v_exp_f32 v76, v76
    v_exp_f32 v77, v77
    v_exp_f32 v78, v78
    v_exp_f32 v79, v79
    v_exp_f32 v80, v80
    v_exp_f32 v81, v81
    v_exp_f32 v82, v82
    v_exp_f32 v83, v83
    v_pk_fma_f32 v[76:77], v[76:77], v[44:45], v[44:45] op_sel_hi:[1,0,0]
    v_pk_fma_f32 v[78:79], v[78:79], v[44:45], v[44:45] op_sel_hi:[1,0,0]
    v_pk_fma_f32 v[80:81], v[80:81], v[44:45], v[44:45] op_sel_hi:[1,0,0]
    v_pk_fma_f32 v[82:83], v[82:83], v[44:45], v[44:45] op_sel_hi:[1,0,0]
    v_rcp_f32 v76, v76
    v_rcp_f32 v77, v77
    v_rcp_f32 v78, v78
    v_rcp_f32 v79, v79
    v_rcp_f32 v80, v80
    v_rcp_f32 v81, v81
    v_rcp_f32 v82, v82
    v_rcp_f32 v83, v83
    v_pk_mul_f32 v[76:77], v[76:77], v[84:85]
    v_pk_mul_f32 v[78:79], v[78:79], v[86:87]
    v_pk_mul_f32 v[80:81], v[80:81], v[88:89]
    v_pk_mul_f32 v[82:83], v[82:83], v[90:91]
    v_cvt_pk_bf16_f32 v84, v76, v77
    v_cvt_pk_bf16_f32 v85, v78, v79
    v_cvt_pk_bf16_f32 v86, v80, v81
    v_cvt_pk_bf16_f32 v87, v82, v83
    buffer_store_dwordx4 v[84:87], v2, s[24:27], s52 offen sc1
    v_pk_mul_f32 v[92:93], v[92:93], v[50:51] op_sel_hi:[1,0]
    v_pk_mul_f32 v[94:95], v[94:95], v[50:51] op_sel_hi:[1,0]
    v_pk_mul_f32 v[96:97], v[96:97], v[50:51] op_sel_hi:[1,0]
    v_pk_mul_f32 v[98:99], v[98:99], v[50:51] op_sel_hi:[1,0]
    v_exp_f32 v92, v92
    v_exp_f32 v93, v93
    v_exp_f32 v94, v94
    v_exp_f32 v95, v95
    v_exp_f32 v96, v96
    v_exp_f32 v97, v97
    v_exp_f32 v98, v98
    v_exp_f32 v99, v99
    v_pk_fma_f32 v[92:93], v[92:93], v[46:47], v[46:47] op_sel_hi:[1,0,0]
    v_pk_fma_f32 v[94:95], v[94:95], v[46:47], v[46:47] op_sel_hi:[1,0,0]
    v_pk_fma_f32 v[96:97], v[96:97], v[46:47], v[46:47] op_sel_hi:[1,0,0]
    v_pk_fma_f32 v[98:99], v[98:99], v[46:47], v[46:47] op_sel_hi:[1,0,0]
    v_rcp_f32 v92, v92
    v_rcp_f32 v93, v93
    v_rcp_f32 v94, v94
    v_rcp_f32 v95, v95
    v_rcp_f32 v96, v96
    v_rcp_f32 v97, v97
    v_rcp_f32 v98, v98
    v_rcp_f32 v99, v99
    v_pk_mul_f32 v[92:93], v[92:93], v[100:101]
    v_pk_mul_f32 v[94:95], v[94:95], v[102:103]
    v_pk_mul_f32 v[96:97], v[96:97], v[104:105]
    v_pk_mul_f32 v[98:99], v[98:99], v[106:107]
    v_cvt_pk_bf16_f32 v100, v92, v93
    v_cvt_pk_bf16_f32 v101, v94, v95
    v_cvt_pk_bf16_f32 v102, v96, v97
    v_cvt_pk_bf16_f32 v103, v98, v99
    buffer_store_dwordx4 v[100:103], v2, s[24:27], s53 offen sc1
    v_pk_mul_f32 v[108:109], v[108:109], v[48:49] op_sel_hi:[1,0]
    v_pk_mul_f32 v[110:111], v[110:111], v[48:49] op_sel_hi:[1,0]
    v_pk_mul_f32 v[112:113], v[112:113], v[48:49] op_sel_hi:[1,0]
    v_pk_mul_f32 v[114:115], v[114:115], v[48:49] op_sel_hi:[1,0]
    v_exp_f32 v108, v108
    v_exp_f32 v109, v109
    v_exp_f32 v110, v110
    v_exp_f32 v111, v111
    v_exp_f32 v112, v112
    v_exp_f32 v113, v113
    v_exp_f32 v114, v114
    v_exp_f32 v115, v115
    v_pk_fma_f32 v[108:109], v[108:109], v[44:45], v[44:45] op_sel_hi:[1,0,0]
    v_pk_fma_f32 v[110:111], v[110:111], v[44:45], v[44:45] op_sel_hi:[1,0,0]
    v_pk_fma_f32 v[112:113], v[112:113], v[44:45], v[44:45] op_sel_hi:[1,0,0]
    v_pk_fma_f32 v[114:115], v[114:115], v[44:45], v[44:45] op_sel_hi:[1,0,0]
    v_rcp_f32 v108, v108
    v_rcp_f32 v109, v109
    v_rcp_f32 v110, v110
    v_rcp_f32 v111, v111
    v_rcp_f32 v112, v112
    v_rcp_f32 v113, v113
    v_rcp_f32 v114, v114
    v_rcp_f32 v115, v115
    v_pk_mul_f32 v[108:109], v[108:109], v[116:117]
    v_pk_mul_f32 v[110:111], v[110:111], v[118:119]
    v_pk_mul_f32 v[112:113], v[112:113], v[120:121]
    v_pk_mul_f32 v[114:115], v[114:115], v[122:123]
    v_cvt_pk_bf16_f32 v116, v108, v109
    v_cvt_pk_bf16_f32 v117, v110, v111
    v_cvt_pk_bf16_f32 v118, v112, v113
    v_cvt_pk_bf16_f32 v119, v114, v115
    buffer_store_dwordx4 v[116:119], v2, s[24:27], s54 offen sc1
    v_pk_mul_f32 v[124:125], v[124:125], v[50:51] op_sel_hi:[1,0]
    v_pk_mul_f32 v[126:127], v[126:127], v[50:51] op_sel_hi:[1,0]
    v_pk_mul_f32 v[128:129], v[128:129], v[50:51] op_sel_hi:[1,0]
    v_pk_mul_f32 v[130:131], v[130:131], v[50:51] op_sel_hi:[1,0]
    v_exp_f32 v124, v124
    v_exp_f32 v125, v125
    v_exp_f32 v126, v126
    v_exp_f32 v127, v127
    v_exp_f32 v128, v128
    v_exp_f32 v129, v129
    v_exp_f32 v130, v130
    v_exp_f32 v131, v131
    v_pk_fma_f32 v[124:125], v[124:125], v[46:47], v[46:47] op_sel_hi:[1,0,0]
    v_pk_fma_f32 v[126:127], v[126:127], v[46:47], v[46:47] op_sel_hi:[1,0,0]
    v_pk_fma_f32 v[128:129], v[128:129], v[46:47], v[46:47] op_sel_hi:[1,0,0]
    v_pk_fma_f32 v[130:131], v[130:131], v[46:47], v[46:47] op_sel_hi:[1,0,0]
    v_rcp_f32 v124, v124
    v_rcp_f32 v125, v125
    v_rcp_f32 v126, v126
    v_rcp_f32 v127, v127
    v_rcp_f32 v128, v128
    v_rcp_f32 v129, v129
    v_rcp_f32 v130, v130
    v_rcp_f32 v131, v131
    v_pk_mul_f32 v[124:125], v[124:125], v[132:133]
    v_pk_mul_f32 v[126:127], v[126:127], v[134:135]
    v_pk_mul_f32 v[128:129], v[128:129], v[136:137]
    v_pk_mul_f32 v[130:131], v[130:131], v[138:139]
    v_cvt_pk_bf16_f32 v132, v124, v125
    v_cvt_pk_bf16_f32 v133, v126, v127
    v_cvt_pk_bf16_f32 v134, v128, v129
    v_cvt_pk_bf16_f32 v135, v130, v131
    buffer_store_dwordx4 v[132:135], v2, s[24:27], s55 offen sc1
    v_pk_mul_f32 v[140:141], v[140:141], v[48:49] op_sel_hi:[1,0]
    v_pk_mul_f32 v[142:143], v[142:143], v[48:49] op_sel_hi:[1,0]
    v_pk_mul_f32 v[144:145], v[144:145], v[48:49] op_sel_hi:[1,0]
    v_pk_mul_f32 v[146:147], v[146:147], v[48:49] op_sel_hi:[1,0]
    v_exp_f32 v140, v140
    v_exp_f32 v141, v141
    v_exp_f32 v142, v142
    v_exp_f32 v143, v143
    v_exp_f32 v144, v144
    v_exp_f32 v145, v145
    v_exp_f32 v146, v146
    v_exp_f32 v147, v147
    v_pk_fma_f32 v[140:141], v[140:141], v[44:45], v[44:45] op_sel_hi:[1,0,0]
    v_pk_fma_f32 v[142:143], v[142:143], v[44:45], v[44:45] op_sel_hi:[1,0,0]
    v_pk_fma_f32 v[144:145], v[144:145], v[44:45], v[44:45] op_sel_hi:[1,0,0]
    v_pk_fma_f32 v[146:147], v[146:147], v[44:45], v[44:45] op_sel_hi:[1,0,0]
    v_rcp_f32 v140, v140
    v_rcp_f32 v141, v141
    v_rcp_f32 v142, v142
    v_rcp_f32 v143, v143
    v_rcp_f32 v144, v144
    v_rcp_f32 v145, v145
    v_rcp_f32 v146, v146
    v_rcp_f32 v147, v147
    v_pk_mul_f32 v[140:141], v[140:141], v[148:149]
    v_pk_mul_f32 v[142:143], v[142:143], v[150:151]
    v_pk_mul_f32 v[144:145], v[144:145], v[152:153]
    v_pk_mul_f32 v[146:147], v[146:147], v[154:155]
    v_cvt_pk_bf16_f32 v148, v140, v141
    v_cvt_pk_bf16_f32 v149, v142, v143
    v_cvt_pk_bf16_f32 v150, v144, v145
    v_cvt_pk_bf16_f32 v151, v146, v147
    buffer_store_dwordx4 v[148:151], v3, s[24:27], s56 offen sc1
    v_pk_mul_f32 v[156:157], v[156:157], v[50:51] op_sel_hi:[1,0]
    v_pk_mul_f32 v[158:159], v[158:159], v[50:51] op_sel_hi:[1,0]
    v_pk_mul_f32 v[160:161], v[160:161], v[50:51] op_sel_hi:[1,0]
    v_pk_mul_f32 v[162:163], v[162:163], v[50:51] op_sel_hi:[1,0]
    v_exp_f32 v156, v156
    v_exp_f32 v157, v157
    v_exp_f32 v158, v158
    v_exp_f32 v159, v159
    v_exp_f32 v160, v160
    v_exp_f32 v161, v161
    v_exp_f32 v162, v162
    v_exp_f32 v163, v163
    v_pk_fma_f32 v[156:157], v[156:157], v[46:47], v[46:47] op_sel_hi:[1,0,0]
    v_pk_fma_f32 v[158:159], v[158:159], v[46:47], v[46:47] op_sel_hi:[1,0,0]
    v_pk_fma_f32 v[160:161], v[160:161], v[46:47], v[46:47] op_sel_hi:[1,0,0]
    v_pk_fma_f32 v[162:163], v[162:163], v[46:47], v[46:47] op_sel_hi:[1,0,0]
    v_rcp_f32 v156, v156
    v_rcp_f32 v157, v157
    v_rcp_f32 v158, v158
    v_rcp_f32 v159, v159
    v_rcp_f32 v160, v160
    v_rcp_f32 v161, v161
    v_rcp_f32 v162, v162
    v_rcp_f32 v163, v163
    v_pk_mul_f32 v[156:157], v[156:157], v[164:165]
    v_pk_mul_f32 v[158:159], v[158:159], v[166:167]
    v_pk_mul_f32 v[160:161], v[160:161], v[168:169]
    v_pk_mul_f32 v[162:163], v[162:163], v[170:171]
    v_cvt_pk_bf16_f32 v164, v156, v157
    v_cvt_pk_bf16_f32 v165, v158, v159
    v_cvt_pk_bf16_f32 v166, v160, v161
    v_cvt_pk_bf16_f32 v167, v162, v163
    buffer_store_dwordx4 v[164:167], v3, s[24:27], s57 offen sc1
    s_barrier
    s_barrier
    s_branch B_end
F_spoll:
    s_mov_b32 s50, 262144
F_spoll2:
    buffer_load_dword v34, v18, s[40:43], s48 offen sc1
    buffer_load_dword v35, v18, s[40:43], s48 offen offset:128 sc1
    buffer_load_dwordx4 v[20:23], v2, s[32:35], s36 offen offset:0 sc1
    buffer_load_dwordx4 v[24:27], v2, s[32:35], s36 offen offset:1024 sc1
    buffer_load_dwordx4 v[28:31], v2, s[32:35], s36 offen offset:2048 sc1
    s_waitcnt vmcnt(0)
    v_max3_u32 v32, v20, v21, v22
    v_max3_u32 v32, v32, v23, v24
    v_max3_u32 v32, v32, v25, v26
    v_max3_u32 v32, v32, v27, v28
    v_max3_u32 v32, v32, v29, v30
    v_max3_u32 v32, v32, v31, v31
    v_max3_u32 v19, v32, v34, v35
    v_cmp_eq_u32 vcc, -1, v19
    s_cbranch_vccz F_sgot
    s_sub_u32 s50, s50, 1
    s_cbranch_scc0 F_spoll2
    s_branch F_sgot
F_idle:
    s_barrier
    s_barrier
    s_barrier
    s_barrier
    s_barrier
    s_barrier
    s_barrier
    s_barrier
    s_barrier
    s_barrier
    s_barrier
    s_barrier
    s_barrier
    s_barrier
    s_barrier
    s_barrier
    s_barrier
    s_branch B_end
F_stat:
    s_mov_b32 s20, s28
    s_mov_b32 s21, s29
    s_mov_b32 s22, 0x158000
    s_mov_b32 s23, 0x20000
    s_lshl_b32 s24, s3, 2
    s_add_u32 s24, s24, s60
    s_lshl_b32 s25, s60, 15
    s_lshl_b32 s26, s61, 12
    s_add_u32 s26, s26, 36864
    s_sub_u32 s26, s25, s26
    v_add_u32 v4, s26, v172
    s_mov_b32 s18, 262144
    s_mov_b32 s27, 0x3f803f80
    v_mov_b32 v16, 0
    v_mov_b32 v17, 0
    v_and_b32 v14, 3, v1
    v_lshlrev_b32 v14, 4, v14
    v_bfe_u32 v15, v1, 2, 1
    v_mul_u32_u24 v15, 16640, v15
    v_add_u32 v14, v15, v14
    v_bfe_u32 v15, v1, 3, 1
    v_lshl_add_u32 v14, v15, 10, v14
    v_lshrrev_b32 v15, 4, v1
    v_lshl_add_u32 v14, v15, 6, v14
    s_and_b32 s28, s24, 7
    s_lshl_b32 s28, s28, 11
    s_mul_i32 s24, s24, 33280
    v_add_u32 v14, s24, v14
    v_add_u32 v15, 256, v14
    v_add_u32 v14, 1024, v14
    v_add_u32 v5, s25, v2
    s_lshl_b32 s8, s3, 2
    s_add_u32 s8, s8, s60
    s_lshl_b32 s8, s8, 7
    v_lshl_add_u32 v6, v1, 13, s8
    s_add_u32 m0, s25, 1024
    s_add_u32 s24, s5, 0
    s_and_b32 s24, s24, 15
    s_lshl_b32 s24, s24, 10
    s_xor_b32 s29, s24, s28
    buffer_load_dwordx4 v14, s[44:47], s29 offen offset:0 sc1 lds
    buffer_load_dwordx4 v15, s[44:47], s29 offen offset:1024 sc1 lds
    s_add_u32 m0, s25, 2560
    s_nop 0
    buffer_load_dwordx4 v14, s[44:47], s29 offen offset:512 sc1 lds
    buffer_load_dwordx4 v15, s[44:47], s29 offen offset:1536 sc1 lds
    s_add_u32 s24, s24, 2048
    s_add_u32 m0, s25, 5120
    s_and_b32 s24, s24, 0x3fff
    s_xor_b32 s29, s24, s28
    buffer_load_dwordx4 v14, s[44:47], s29 offen offset:0 sc1 lds
    buffer_load_dwordx4 v15, s[44:47], s29 offen offset:1024 sc1 lds
    s_add_u32 m0, s25, 6656
    s_nop 0
    buffer_load_dwordx4 v14, s[44:47], s29 offen offset:512 sc1 lds
    buffer_load_dwordx4 v15, s[44:47], s29 offen offset:1536 sc1 lds
    s_add_u32 s24, s24, 2048
    s_add_u32 m0, s25, 9216
    s_and_b32 s24, s24, 0x3fff
    s_xor_b32 s29, s24, s28
    buffer_load_dwordx4 v14, s[44:47], s29 offen offset:0 sc1 lds
    buffer_load_dwordx4 v15, s[44:47], s29 offen offset:1024 sc1 lds
    s_add_u32 m0, s25, 10752
    s_nop 0
    buffer_load_dwordx4 v14, s[44:47], s29 offen offset:512 sc1 lds
    buffer_load_dwordx4 v15, s[44:47], s29 offen offset:1536 sc1 lds
    s_add_u32 s24, s24, 2048
    s_waitcnt vmcnt(10)
    ds_read_b64_tr_b16 v[40:41], v4 offset:1024
    ds_read_b64_tr_b16 v[42:43], v4 offset:1280
    ds_read_b64_tr_b16 v[44:45], v4 offset:2048
    ds_read_b64_tr_b16 v[46:47], v4 offset:2304
    ds_read_b64 v[48:49], v5 offset:1032
    ds_read_b64 v[50:51], v5 offset:2056
    s_add_u32 m0, s25, 13312
    s_and_b32 s24, s24, 0x3fff
    s_xor_b32 s29, s24, s28
    buffer_load_dwordx4 v14, s[44:47], s29 offen offset:0 sc1 lds
    buffer_load_dwordx4 v15, s[44:47], s29 offen offset:1024 sc1 lds
    s_waitcnt vmcnt(10)
    ds_read_b64_tr_b16 v[52:53], v4 offset:3072
    ds_read_b64_tr_b16 v[54:55], v4 offset:3328
    ds_read_b64_tr_b16 v[56:57], v4 offset:4096
    ds_read_b64_tr_b16 v[58:59], v4 offset:4352
    ds_read_b64 v[60:61], v5 offset:3080
    ds_read_b64 v[62:63], v5 offset:4104
    s_waitcnt lgkmcnt(6)
    v_cmp_eq_u64 vcc, v[48:49], v[220:221]
    v_cmp_eq_u64 s[14:15], v[50:51], v[220:221]
    s_nop 0
    s_or_b64 vcc, vcc, s[14:15]
    s_cbranch_scc1 F_sr0
F_sb0:
    v_dot2_f32_bf16 v16, v40, s27, v16
    v_dot2_f32_bf16 v17, v40, v40, v17
    v_dot2_f32_bf16 v16, v41, s27, v16
    v_dot2_f32_bf16 v17, v41, v41, v17
    v_dot2_f32_bf16 v16, v42, s27, v16
    v_dot2_f32_bf16 v17, v42, v42, v17
    v_dot2_f32_bf16 v16, v43, s27, v16
    v_dot2_f32_bf16 v17, v43, v43, v17
    v_dot2_f32_bf16 v16, v44, s27, v16
    v_dot2_f32_bf16 v17, v44, v44, v17
    v_dot2_f32_bf16 v16, v45, s27, v16
    v_dot2_f32_bf16 v17, v45, v45, v17
    v_dot2_f32_bf16 v16, v46, s27, v16
    v_dot2_f32_bf16 v17, v46, v46, v17
    v_dot2_f32_bf16 v16, v47, s27, v16
    v_dot2_f32_bf16 v17, v47, v47, v17
    s_add_u32 m0, s25, 14848
    s_nop 0
    buffer_load_dwordx4 v14, s[44:47], s29 offen offset:512 sc1 lds
    buffer_load_dwordx4 v15, s[44:47], s29 offen offset:1536 sc1 lds
    s_add_u32 s24, s24, 2048
    s_waitcnt vmcnt(10)
    ds_read_b64_tr_b16 v[40:41], v4 offset:5120
    ds_read_b64_tr_b16 v[42:43], v4 offset:5376
    ds_read_b64_tr_b16 v[44:45], v4 offset:6144
    ds_read_b64_tr_b16 v[46:47], v4 offset:6400
    ds_read_b64 v[48:49], v5 offset:5128
    ds_read_b64 v[50:51], v5 offset:6152
    s_waitcnt lgkmcnt(6)
    v_cmp_eq_u64 vcc, v[60:61], v[220:221]
    v_cmp_eq_u64 s[14:15], v[62:63], v[220:221]
    s_nop 0
    s_or_b64 vcc, vcc, s[14:15]
    s_cbranch_scc1 F_sr1
F_sb1:
    v_dot2_f32_bf16 v16, v52, s27, v16
    v_dot2_f32_bf16 v17, v52, v52, v17
    v_dot2_f32_bf16 v16, v53, s27, v16
    v_dot2_f32_bf16 v17, v53, v53, v17
    v_dot2_f32_bf16 v16, v54, s27, v16
    v_dot2_f32_bf16 v17, v54, v54, v17
    v_dot2_f32_bf16 v16, v55, s27, v16
    v_dot2_f32_bf16 v17, v55, v55, v17
    v_dot2_f32_bf16 v16, v56, s27, v16
    v_dot2_f32_bf16 v17, v56, v56, v17
    v_dot2_f32_bf16 v16, v57, s27, v16
    v_dot2_f32_bf16 v17, v57, v57, v17
    v_dot2_f32_bf16 v16, v58, s27, v16
    v_dot2_f32_bf16 v17, v58, v58, v17
    v_dot2_f32_bf16 v16, v59, s27, v16
    v_dot2_f32_bf16 v17, v59, v59, v17
    s_add_u32 m0, s25, 17408
    s_and_b32 s24, s24, 0x3fff
    s_xor_b32 s29, s24, s28
    buffer_load_dwordx4 v14, s[44:47], s29 offen offset:0 sc1 lds
    buffer_load_dwordx4 v15, s[44:47], s29 offen offset:1024 sc1 lds
    s_waitcnt vmcnt(10)
    ds_read_b64_tr_b16 v[52:53], v4 offset:7168
    ds_read_b64_tr_b16 v[54:55], v4 offset:7424
    ds_read_b64_tr_b16 v[56:57], v4 offset:8192
    ds_read_b64_tr_b16 v[58:59], v4 offset:8448
    ds_read_b64 v[60:61], v5 offset:7176
    ds_read_b64 v[62:63], v5 offset:8200
    s_waitcnt lgkmcnt(6)
    v_cmp_eq_u64 vcc, v[48:49], v[220:221]
    v_cmp_eq_u64 s[14:15], v[50:51], v[220:221]
    s_nop 0
    s_or_b64 vcc, vcc, s[14:15]
    s_cbranch_scc1 F_sr2
F_sb2:
    v_dot2_f32_bf16 v16, v40, s27, v16
    v_dot2_f32_bf16 v17, v40, v40, v17
    v_dot2_f32_bf16 v16, v41, s27, v16
    v_dot2_f32_bf16 v17, v41, v41, v17
    v_dot2_f32_bf16 v16, v42, s27, v16
    v_dot2_f32_bf16 v17, v42, v42, v17
    v_dot2_f32_bf16 v16, v43, s27, v16
    v_dot2_f32_bf16 v17, v43, v43, v17
    v_dot2_f32_bf16 v16, v44, s27, v16
    v_dot2_f32_bf16 v17, v44, v44, v17
    v_dot2_f32_bf16 v16, v45, s27, v16
    v_dot2_f32_bf16 v17, v45, v45, v17
    v_dot2_f32_bf16 v16, v46, s27, v16
    v_dot2_f32_bf16 v17, v46, v46, v17
    v_dot2_f32_bf16 v16, v47, s27, v16
    v_dot2_f32_bf16 v17, v47, v47, v17
    s_add_u32 m0, s25, 18944
    s_nop 0
    buffer_load_dwordx4 v14, s[44:47], s29 offen offset:512 sc1 lds
    buffer_load_dwordx4 v15, s[44:47], s29 offen offset:1536 sc1 lds
    s_add_u32 s24, s24, 2048
    s_waitcnt vmcnt(10)
    ds_read_b64_tr_b16 v[40:41], v4 offset:9216
    ds_read_b64_tr_b16 v[42:43], v4 offset:9472
    ds_read_b64_tr_b16 v[44:45], v4 offset:10240
    ds_read_b64_tr_b16 v[46:47], v4 offset:10496
    ds_read_b64 v[48:49], v5 offset:9224
    ds_read_b64 v[50:51], v5 offset:10248
    s_waitcnt lgkmcnt(6)
    v_cmp_eq_u64 vcc, v[60:61], v[220:221]
    v_cmp_eq_u64 s[14:15], v[62:63], v[220:221]
    s_nop 0
    s_or_b64 vcc, vcc, s[14:15]
    s_cbranch_scc1 F_sr3
F_sb3:
    v_dot2_f32_bf16 v16, v52, s27, v16
    v_dot2_f32_bf16 v17, v52, v52, v17
    v_dot2_f32_bf16 v16, v53, s27, v16
    v_dot2_f32_bf16 v17, v53, v53, v17
    v_dot2_f32_bf16 v16, v54, s27, v16
    v_dot2_f32_bf16 v17, v54, v54, v17
    v_dot2_f32_bf16 v16, v55, s27, v16
    v_dot2_f32_bf16 v17, v55, v55, v17
    v_dot2_f32_bf16 v16, v56, s27, v16
    v_dot2_f32_bf16 v17, v56, v56, v17
    v_dot2_f32_bf16 v16, v57, s27, v16
    v_dot2_f32_bf16 v17, v57, v57, v17
    v_dot2_f32_bf16 v16, v58, s27, v16
    v_dot2_f32_bf16 v17, v58, v58, v17
    v_dot2_f32_bf16 v16, v59, s27, v16
    v_dot2_f32_bf16 v17, v59, v59, v17
    s_add_u32 m0, s25, 21504
    s_and_b32 s24, s24, 0x3fff
    s_xor_b32 s29, s24, s28
    buffer_load_dwordx4 v14, s[44:47], s29 offen offset:0 sc1 lds
    buffer_load_dwordx4 v15, s[44:47], s29 offen offset:1024 sc1 lds
    s_waitcnt vmcnt(10)
    ds_read_b64_tr_b16 v[52:53], v4 offset:11264
    ds_read_b64_tr_b16 v[54:55], v4 offset:11520
    ds_read_b64_tr_b16 v[56:57], v4 offset:12288
    ds_read_b64_tr_b16 v[58:59], v4 offset:12544
    ds_read_b64 v[60:61], v5 offset:11272
    ds_read_b64 v[62:63], v5 offset:12296
    s_waitcnt lgkmcnt(6)
    v_cmp_eq_u64 vcc, v[48:49], v[220:221]
    v_cmp_eq_u64 s[14:15], v[50:51], v[220:221]
    s_nop 0
    s_or_b64 vcc, vcc, s[14:15]
    s_cbranch_scc1 F_sr4
F_sb4:
    v_dot2_f32_bf16 v16, v40, s27, v16
    v_dot2_f32_bf16 v17, v40, v40, v17
    v_dot2_f32_bf16 v16, v41, s27, v16
    v_dot2_f32_bf16 v17, v41, v41, v17
    v_dot2_f32_bf16 v16, v42, s27, v16
    v_dot2_f32_bf16 v17, v42, v42, v17
    v_dot2_f32_bf16 v16, v43, s27, v16
    v_dot2_f32_bf16 v17, v43, v43, v17
    v_dot2_f32_bf16 v16, v44, s27, v16
    v_dot2_f32_bf16 v17, v44, v44, v17
    v_dot2_f32_bf16 v16, v45, s27, v16
    v_dot2_f32_bf16 v17, v45, v45, v17
    v_dot2_f32_bf16 v16, v46, s27, v16
    v_dot2_f32_bf16 v17, v46, v46, v17
    v_dot2_f32_bf16 v16, v47, s27, v16
    v_dot2_f32_bf16 v17, v47, v47, v17
    s_add_u32 m0, s25, 23040
    s_nop 0
    buffer_load_dwordx4 v14, s[44:47], s29 offen offset:512 sc1 lds
    buffer_load_dwordx4 v15, s[44:47], s29 offen offset:1536 sc1 lds
    s_add_u32 s24, s24, 2048
    s_waitcnt vmcnt(10)
    ds_read_b64_tr_b16 v[40:41], v4 offset:13312
    ds_read_b64_tr_b16 v[42:43], v4 offset:13568
    ds_read_b64_tr_b16 v[44:45], v4 offset:14336
    ds_read_b64_tr_b16 v[46:47], v4 offset:14592
    ds_read_b64 v[48:49], v5 offset:13320
    ds_read_b64 v[50:51], v5 offset:14344
    s_waitcnt lgkmcnt(6)
    v_cmp_eq_u64 vcc, v[60:61], v[220:221]
    v_cmp_eq_u64 s[14:15], v[62:63], v[220:221]
    s_nop 0
    s_or_b64 vcc, vcc, s[14:15]
    s_cbranch_scc1 F_sr5
F_sb5:
    v_dot2_f32_bf16 v16, v52, s27, v16
    v_dot2_f32_bf16 v17, v52, v52, v17
    v_dot2_f32_bf16 v16, v53, s27, v16
    v_dot2_f32_bf16 v17, v53, v53, v17
    v_dot2_f32_bf16 v16, v54, s27, v16
    v_dot2_f32_bf16 v17, v54, v54, v17
    v_dot2_f32_bf16 v16, v55, s27, v16
    v_dot2_f32_bf16 v17, v55, v55, v17
    v_dot2_f32_bf16 v16, v56, s27, v16
    v_dot2_f32_bf16 v17, v56, v56, v17
    v_dot2_f32_bf16 v16, v57, s27, v16
    v_dot2_f32_bf16 v17, v57, v57, v17
    v_dot2_f32_bf16 v16, v58, s27, v16
    v_dot2_f32_bf16 v17, v58, v58, v17
    v_dot2_f32_bf16 v16, v59, s27, v16
    v_dot2_f32_bf16 v17, v59, v59, v17
    s_add_u32 m0, s25, 25600
    s_and_b32 s24, s24, 0x3fff
    s_xor_b32 s29, s24, s28
    buffer_load_dwordx4 v14, s[44:47], s29 offen offset:0 sc1 lds
    buffer_load_dwordx4 v15, s[44:47], s29 offen offset:1024 sc1 lds
    s_waitcnt vmcnt(10)
    ds_read_b64_tr_b16 v[52:53], v4 offset:15360
    ds_read_b64_tr_b16 v[54:55], v4 offset:15616
    ds_read_b64_tr_b16 v[56:57], v4 offset:16384
    ds_read_b64_tr_b16 v[58:59], v4 offset:16640
    ds_read_b64 v[60:61], v5 offset:15368
    ds_read_b64 v[62:63], v5 offset:16392
    s_waitcnt lgkmcnt(6)
    v_cmp_eq_u64 vcc, v[48:49], v[220:221]
    v_cmp_eq_u64 s[14:15], v[50:51], v[220:221]
    s_nop 0
    s_or_b64 vcc, vcc, s[14:15]
    s_cbranch_scc1 F_sr6
F_sb6:
    v_dot2_f32_bf16 v16, v40, s27, v16
    v_dot2_f32_bf16 v17, v40, v40, v17
    v_dot2_f32_bf16 v16, v41, s27, v16
    v_dot2_f32_bf16 v17, v41, v41, v17
    v_dot2_f32_bf16 v16, v42, s27, v16
    v_dot2_f32_bf16 v17, v42, v42, v17
    v_dot2_f32_bf16 v16, v43, s27, v16
    v_dot2_f32_bf16 v17, v43, v43, v17
    v_dot2_f32_bf16 v16, v44, s27, v16
    v_dot2_f32_bf16 v17, v44, v44, v17
    v_dot2_f32_bf16 v16, v45, s27, v16
    v_dot2_f32_bf16 v17, v45, v45, v17
    v_dot2_f32_bf16 v16, v46, s27, v16
    v_dot2_f32_bf16 v17, v46, v46, v17
    v_dot2_f32_bf16 v16, v47, s27, v16
    v_dot2_f32_bf16 v17, v47, v47, v17
    s_add_u32 m0, s25, 27136
    s_nop 0
    buffer_load_dwordx4 v14, s[44:47], s29 offen offset:512 sc1 lds
    buffer_load_dwordx4 v15, s[44:47], s29 offen offset:1536 sc1 lds
    s_add_u32 s24, s24, 2048
    s_waitcnt vmcnt(10)
    ds_read_b64_tr_b16 v[40:41], v4 offset:17408
    ds_read_b64_tr_b16 v[42:43], v4 offset:17664
    ds_read_b64_tr_b16 v[44:45], v4 offset:18432
    ds_read_b64_tr_b16 v[46:47], v4 offset:18688
    ds_read_b64 v[48:49], v5 offset:17416
    ds_read_b64 v[50:51], v5 offset:18440
    s_waitcnt lgkmcnt(6)
    v_cmp_eq_u64 vcc, v[60:61], v[220:221]
    v_cmp_eq_u64 s[14:15], v[62:63], v[220:221]
    s_nop 0
    s_or_b64 vcc, vcc, s[14:15]
    s_cbranch_scc1 F_sr7
F_sb7:
    v_dot2_f32_bf16 v16, v52, s27, v16
    v_dot2_f32_bf16 v17, v52, v52, v17
    v_dot2_f32_bf16 v16, v53, s27, v16
    v_dot2_f32_bf16 v17, v53, v53, v17
    v_dot2_f32_bf16 v16, v54, s27, v16
    v_dot2_f32_bf16 v17, v54, v54, v17
    v_dot2_f32_bf16 v16, v55, s27, v16
    v_dot2_f32_bf16 v17, v55, v55, v17
    v_dot2_f32_bf16 v16, v56, s27, v16
    v_dot2_f32_bf16 v17, v56, v56, v17
    v_dot2_f32_bf16 v16, v57, s27, v16
    v_dot2_f32_bf16 v17, v57, v57, v17
    v_dot2_f32_bf16 v16, v58, s27, v16
    v_dot2_f32_bf16 v17, v58, v58, v17
    v_dot2_f32_bf16 v16, v59, s27, v16
    v_dot2_f32_bf16 v17, v59, v59, v17
    s_add_u32 m0, s25, 29696
    s_and_b32 s24, s24, 0x3fff
    s_xor_b32 s29, s24, s28
    buffer_load_dwordx4 v14, s[44:47], s29 offen offset:0 sc1 lds
    buffer_load_dwordx4 v15, s[44:47], s29 offen offset:1024 sc1 lds
    s_waitcnt vmcnt(10)
    ds_read_b64_tr_b16 v[52:53], v4 offset:19456
    ds_read_b64_tr_b16 v[54:55], v4 offset:19712
    ds_read_b64_tr_b16 v[56:57], v4 offset:20480
    ds_read_b64_tr_b16 v[58:59], v4 offset:20736
    ds_read_b64 v[60:61], v5 offset:19464
    ds_read_b64 v[62:63], v5 offset:20488
    s_waitcnt lgkmcnt(6)
    v_cmp_eq_u64 vcc, v[48:49], v[220:221]
    v_cmp_eq_u64 s[14:15], v[50:51], v[220:221]
    s_nop 0
    s_or_b64 vcc, vcc, s[14:15]
    s_cbranch_scc1 F_sr8
F_sb8:
    v_dot2_f32_bf16 v16, v40, s27, v16
    v_dot2_f32_bf16 v17, v40, v40, v17
    v_dot2_f32_bf16 v16, v41, s27, v16
    v_dot2_f32_bf16 v17, v41, v41, v17
    v_dot2_f32_bf16 v16, v42, s27, v16
    v_dot2_f32_bf16 v17, v42, v42, v17
    v_dot2_f32_bf16 v16, v43, s27, v16
    v_dot2_f32_bf16 v17, v43, v43, v17
    v_dot2_f32_bf16 v16, v44, s27, v16
    v_dot2_f32_bf16 v17, v44, v44, v17
    v_dot2_f32_bf16 v16, v45, s27, v16
    v_dot2_f32_bf16 v17, v45, v45, v17
    v_dot2_f32_bf16 v16, v46, s27, v16
    v_dot2_f32_bf16 v17, v46, v46, v17
    v_dot2_f32_bf16 v16, v47, s27, v16
    v_dot2_f32_bf16 v17, v47, v47, v17
    s_add_u32 m0, s25, 31232
    s_nop 0
    buffer_load_dwordx4 v14, s[44:47], s29 offen offset:512 sc1 lds
    buffer_load_dwordx4 v15, s[44:47], s29 offen offset:1536 sc1 lds
    s_add_u32 s24, s24, 2048
    s_mov_b32 s8, 0
    buffer_load_dword v10, v6, s[20:23], s8 offen
    s_mov_b32 s8, 524288
    buffer_load_dword v11, v6, s[20:23], s8 offen
    s_mov_b32 s8, 1048576
    buffer_load_dword v12, v6, s[20:23], s8 offen
    s_waitcnt vmcnt(13)
    ds_read_b64_tr_b16 v[40:41], v4 offset:21504
    ds_read_b64_tr_b16 v[42:43], v4 offset:21760
    ds_read_b64_tr_b16 v[44:45], v4 offset:22528
    ds_read_b64_tr_b16 v[46:47], v4 offset:22784
    ds_read_b64 v[48:49], v5 offset:21512
    ds_read_b64 v[50:51], v5 offset:22536
    s_waitcnt lgkmcnt(6)
    v_cmp_eq_u64 vcc, v[60:61], v[220:221]
    v_cmp_eq_u64 s[14:15], v[62:63], v[220:221]
    s_nop 0
    s_or_b64 vcc, vcc, s[14:15]
    s_cbranch_scc1 F_sr9
F_sb9:
    v_dot2_f32_bf16 v16, v52, s27, v16
    v_dot2_f32_bf16 v17, v52, v52, v17
    v_dot2_f32_bf16 v16, v53, s27, v16
    v_dot2_f32_bf16 v17, v53, v53, v17
    v_dot2_f32_bf16 v16, v54, s27, v16
    v_dot2_f32_bf16 v17, v54, v54, v17
    v_dot2_f32_bf16 v16, v55, s27, v16
    v_dot2_f32_bf16 v17, v55, v55, v17
    v_dot2_f32_bf16 v16, v56, s27, v16
    v_dot2_f32_bf16 v17, v56, v56, v17
    v_dot2_f32_bf16 v16, v57, s27, v16
    v_dot2_f32_bf16 v17, v57, v57, v17
    v_dot2_f32_bf16 v16, v58, s27, v16
    v_dot2_f32_bf16 v17, v58, v58, v17
    v_dot2_f32_bf16 v16, v59, s27, v16
    v_dot2_f32_bf16 v17, v59, v59, v17
    s_waitcnt vmcnt(11)
    ds_read_b64_tr_b16 v[52:53], v4 offset:23552
    ds_read_b64_tr_b16 v[54:55], v4 offset:23808
    ds_read_b64_tr_b16 v[56:57], v4 offset:24576
    ds_read_b64_tr_b16 v[58:59], v4 offset:24832
    ds_read_b64 v[60:61], v5 offset:23560
    ds_read_b64 v[62:63], v5 offset:24584
    s_waitcnt lgkmcnt(6)
    v_cmp_eq_u64 vcc, v[48:49], v[220:221]
    v_cmp_eq_u64 s[14:15], v[50:51], v[220:221]
    s_nop 0
    s_or_b64 vcc, vcc, s[14:15]
    s_cbranch_scc1 F_sr10
F_sb10:
    v_dot2_f32_bf16 v16, v40, s27, v16
    v_dot2_f32_bf16 v17, v40, v40, v17
    v_dot2_f32_bf16 v16, v41, s27, v16
    v_dot2_f32_bf16 v17, v41, v41, v17
    v_dot2_f32_bf16 v16, v42, s27, v16
    v_dot2_f32_bf16 v17, v42, v42, v17
    v_dot2_f32_bf16 v16, v43, s27, v16
    v_dot2_f32_bf16 v17, v43, v43, v17
    v_dot2_f32_bf16 v16, v44, s27, v16
    v_dot2_f32_bf16 v17, v44, v44, v17
    v_dot2_f32_bf16 v16, v45, s27, v16
    v_dot2_f32_bf16 v17, v45, v45, v17
    v_dot2_f32_bf16 v16, v46, s27, v16
    v_dot2_f32_bf16 v17, v46, v46, v17
    v_dot2_f32_bf16 v16, v47, s27, v16
    v_dot2_f32_bf16 v17, v47, v47, v17
    s_waitcnt vmcnt(9)
    ds_read_b64_tr_b16 v[40:41], v4 offset:25600
    ds_read_b64_tr_b16 v[42:43], v4 offset:25856
    ds_read_b64_tr_b16 v[44:45], v4 offset:26624
    ds_read_b64_tr_b16 v[46:47], v4 offset:26880
    ds_read_b64 v[48:49], v5 offset:25608
    ds_read_b64 v[50:51], v5 offset:26632
    s_waitcnt lgkmcnt(6)
    v_cmp_eq_u64 vcc, v[60:61], v[220:221]
    v_cmp_eq_u64 s[14:15], v[62:63], v[220:221]
    s_nop 0
    s_or_b64 vcc, vcc, s[14:15]
    s_cbranch_scc1 F_sr11
F_sb11:
    v_dot2_f32_bf16 v16, v52, s27, v16
    v_dot2_f32_bf16 v17, v52, v52, v17
    v_dot2_f32_bf16 v16, v53, s27, v16
    v_dot2_f32_bf16 v17, v53, v53, v17
    v_dot2_f32_bf16 v16, v54, s27, v16
    v_dot2_f32_bf16 v17, v54, v54, v17
    v_dot2_f32_bf16 v16, v55, s27, v16
    v_dot2_f32_bf16 v17, v55, v55, v17
    v_dot2_f32_bf16 v16, v56, s27, v16
    v_dot2_f32_bf16 v17, v56, v56, v17
    v_dot2_f32_bf16 v16, v57, s27, v16
    v_dot2_f32_bf16 v17, v57, v57, v17
    v_dot2_f32_bf16 v16, v58, s27, v16
    v_dot2_f32_bf16 v17, v58, v58, v17
    v_dot2_f32_bf16 v16, v59, s27, v16
    v_dot2_f32_bf16 v17, v59, v59, v17
    s_waitcnt vmcnt(7)
    ds_read_b64_tr_b16 v[52:53], v4 offset:27648
    ds_read_b64_tr_b16 v[54:55], v4 offset:27904
    ds_read_b64_tr_b16 v[56:57], v4 offset:28672
    ds_read_b64_tr_b16 v[58:59], v4 offset:28928
    ds_read_b64 v[60:61], v5 offset:27656
    ds_read_b64 v[62:63], v5 offset:28680
    s_waitcnt lgkmcnt(6)
    v_cmp_eq_u64 vcc, v[48:49], v[220:221]
    v_cmp_eq_u64 s[14:15], v[50:51], v[220:221]
    s_nop 0
    s_or_b64 vcc, vcc, s[14:15]
    s_cbranch_scc1 F_sr12
F_sb12:
    v_dot2_f32_bf16 v16, v40, s27, v16
    v_dot2_f32_bf16 v17, v40, v40, v17
    v_dot2_f32_bf16 v16, v41, s27, v16
    v_dot2_f32_bf16 v17, v41, v41, v17
    v_dot2_f32_bf16 v16, v42, s27, v16
    v_dot2_f32_bf16 v17, v42, v42, v17
    v_dot2_f32_bf16 v16, v43, s27, v16
    v_dot2_f32_bf16 v17, v43, v43, v17
    v_dot2_f32_bf16 v16, v44, s27, v16
    v_dot2_f32_bf16 v17, v44, v44, v17
    v_dot2_f32_bf16 v16, v45, s27, v16
    v_dot2_f32_bf16 v17, v45, v45, v17
    v_dot2_f32_bf16 v16, v46, s27, v16
    v_dot2_f32_bf16 v17, v46, v46, v17
    v_dot2_f32_bf16 v16, v47, s27, v16
    v_dot2_f32_bf16 v17, v47, v47, v17
    s_waitcnt vmcnt(5)
    ds_read_b64_tr_b16 v[40:41], v4 offset:29696
    ds_read_b64_tr_b16 v[42:43], v4 offset:29952
    ds_read_b64_tr_b16 v[44:45], v4 offset:30720
    ds_read_b64_tr_b16 v[46:47], v4 offset:30976
    ds_read_b64 v[48:49], v5 offset:29704
    ds_read_b64 v[50:51], v5 offset:30728
    s_waitcnt lgkmcnt(6)
    v_cmp_eq_u64 vcc, v[60:61], v[220:221]
    v_cmp_eq_u64 s[14:15], v[62:63], v[220:221]
    s_nop 0
    s_or_b64 vcc, vcc, s[14:15]
    s_cbranch_scc1 F_sr13
F_sb13:
    v_dot2_f32_bf16 v16, v52, s27, v16
    v_dot2_f32_bf16 v17, v52, v52, v17
    v_dot2_f32_bf16 v16, v53, s27, v16
    v_dot2_f32_bf16 v17, v53, v53, v17
    v_dot2_f32_bf16 v16, v54, s27, v16
    v_dot2_f32_bf16 v17, v54, v54, v17
    v_dot2_f32_bf16 v16, v55, s27, v16
    v_dot2_f32_bf16 v17, v55, v55, v17
    v_dot2_f32_bf16 v16, v56, s27, v16
    v_dot2_f32_bf16 v17, v56, v56, v17
    v_dot2_f32_bf16 v16, v57, s27, v16
    v_dot2_f32_bf16 v17, v57, v57, v17
    v_dot2_f32_bf16 v16, v58, s27, v16
    v_dot2_f32_bf16 v17, v58, v58, v17
    v_dot2_f32_bf16 v16, v59, s27, v16
    v_dot2_f32_bf16 v17, v59, v59, v17
    s_waitcnt vmcnt(3)
    ds_read_b64_tr_b16 v[52:53], v4 offset:31744
    ds_read_b64_tr_b16 v[54:55], v4 offset:32000
    ds_read_b64_tr_b16 v[56:57], v4 offset:32768
    ds_read_b64_tr_b16 v[58:59], v4 offset:33024
    ds_read_b64 v[60:61], v5 offset:31752
    ds_read_b64 v[62:63], v5 offset:32776
    s_waitcnt lgkmcnt(6)
    v_cmp_eq_u64 vcc, v[48:49], v[220:221]
    v_cmp_eq_u64 s[14:15], v[50:51], v[220:221]
    s_nop 0
    s_or_b64 vcc, vcc, s[14:15]
    s_cbranch_scc1 F_sr14
F_sb14:
    v_dot2_f32_bf16 v16, v40, s27, v16
    v_dot2_f32_bf16 v17, v40, v40, v17
    v_dot2_f32_bf16 v16, v41, s27, v16
    v_dot2_f32_bf16 v17, v41, v41, v17
    v_dot2_f32_bf16 v16, v42, s27, v16
    v_dot2_f32_bf16 v17, v42, v42, v17
    v_dot2_f32_bf16 v16, v43, s27, v16
    v_dot2_f32_bf16 v17, v43, v43, v17
    v_dot2_f32_bf16 v16, v44, s27, v16
    v_dot2_f32_bf16 v17, v44, v44, v17
    v_dot2_f32_bf16 v16, v45, s27, v16
    v_dot2_f32_bf16 v17, v45, v45, v17
    v_dot2_f32_bf16 v16, v46, s27, v16
    v_dot2_f32_bf16 v17, v46, v46, v17
    v_dot2_f32_bf16 v16, v47, s27, v16
    v_dot2_f32_bf16 v17, v47, v47, v17
    s_waitcnt lgkmcnt(0)
    v_cmp_eq_u64 vcc, v[60:61], v[220:221]
    v_cmp_eq_u64 s[14:15], v[62:63], v[220:221]
    s_nop 0
    s_or_b64 vcc, vcc, s[14:15]
    s_cbranch_scc1 F_sr15
F_sb15:
    v_dot2_f32_bf16 v16, v52, s27, v16
    v_dot2_f32_bf16 v17, v52, v52, v17
    v_dot2_f32_bf16 v16, v53, s27, v16
    v_dot2_f32_bf16 v17, v53, v53, v17
    v_dot2_f32_bf16 v16, v54, s27, v16
    v_dot2_f32_bf16 v17, v54, v54, v17
    v_dot2_f32_bf16 v16, v55, s27, v16
    v_dot2_f32_bf16 v17, v55, v55, v17
    v_dot2_f32_bf16 v16, v56, s27, v16
    v_dot2_f32_bf16 v17, v56, v56, v17
    v_dot2_f32_bf16 v16, v57, s27, v16
    v_dot2_f32_bf16 v17, v57, v57, v17
    v_dot2_f32_bf16 v16, v58, s27, v16
    v_dot2_f32_bf16 v17, v58, v58, v17
    v_dot2_f32_bf16 v16, v59, s27, v16
    v_dot2_f32_bf16 v17, v59, v59, v17
    s_barrier
    s_nop 1
    v_permlane32_swap_b32 v16, v17
    v_add_f32 v16, v16, v17
    v_mul_f32 v16, 0x3b000000, v16
    v_mov_b32 v17, v16
    s_nop 1
    v_permlane32_swap_b32 v16, v17
    v_fma_f32 v17, -v16, v16, v17
    v_max_f32 v17, 0, v17
    v_cvt_pk_bf16_f32 v17, v17, v17
    v_and_b32 v17, 0xffff0000, v17
    v_add_f32 v17, 0x3727c5ac, v17
    v_cvt_pk_bf16_f32 v17, v17, v17
    v_and_b32 v17, 0xffff0000, v17
    v_sqrt_f32 v17, v17
    s_nop 0
    v_cvt_pk_bf16_f32 v16, -v16, v17
    s_lshl_b32 s8, s3, 2
    s_add_u32 s8, s8, s60
    s_lshl_b32 s8, s8, 7
    s_add_u32 s8, s8, 219136
    s_mov_b32 exec_hi, 0
    buffer_store_dword v16, v18, s[40:43], s8 offen sc1
    s_mov_b64 exec, -1
    s_barrier
    s_branch B_end
F_sr0:
    s_sub_u32 s18, s18, 1
    s_cbranch_scc1 F_sx0
    s_add_u32 m0, s25, 1024
    s_add_u32 s63, s5, 0
    s_and_b32 s63, s63, 15
    s_lshl_b32 s63, s63, 10
    s_xor_b32 s63, s63, s28
    buffer_load_dwordx4 v14, s[44:47], s63 offen offset:0 sc1 lds
    buffer_load_dwordx4 v15, s[44:47], s63 offen offset:1024 sc1 lds
    s_waitcnt vmcnt(0)
    ds_read_b64_tr_b16 v[40:41], v4 offset:1024
    ds_read_b64_tr_b16 v[42:43], v4 offset:1280
    ds_read_b64_tr_b16 v[44:45], v4 offset:2048
    ds_read_b64_tr_b16 v[46:47], v4 offset:2304
    ds_read_b64 v[48:49], v5 offset:1032
    ds_read_b64 v[50:51], v5 offset:2056
    s_waitcnt lgkmcnt(0)
    v_cmp_eq_u64 vcc, v[48:49], v[220:221]
    v_cmp_eq_u64 s[14:15], v[50:51], v[220:221]
    s_nop 0
    s_or_b64 vcc, vcc, s[14:15]
    s_cbranch_scc1 F_sr0
    s_branch F_sb0
F_sx0:
    s_mov_b32 s18, 0
    s_branch F_sb0
F_sr1:
    s_sub_u32 s18, s18, 1
    s_cbranch_scc1 F_sx1
    s_add_u32 m0, s25, 2560
    s_add_u32 s63, s5, 0
    s_and_b32 s63, s63, 15
    s_lshl_b32 s63, s63, 10
    s_xor_b32 s63, s63, s28
    buffer_load_dwordx4 v14, s[44:47], s63 offen offset:512 sc1 lds
    buffer_load_dwordx4 v15, s[44:47], s63 offen offset:1536 sc1 lds
    s_waitcnt vmcnt(0)
    ds_read_b64_tr_b16 v[52:53], v4 offset:3072
    ds_read_b64_tr_b16 v[54:55], v4 offset:3328
    ds_read_b64_tr_b16 v[56:57], v4 offset:4096
    ds_read_b64_tr_b16 v[58:59], v4 offset:4352
    ds_read_b64 v[60:61], v5 offset:3080
    ds_read_b64 v[62:63], v5 offset:4104
    s_waitcnt lgkmcnt(0)
    v_cmp_eq_u64 vcc, v[60:61], v[220:221]
    v_cmp_eq_u64 s[14:15], v[62:63], v[220:221]
    s_nop 0
    s_or_b64 vcc, vcc, s[14:15]
    s_cbranch_scc1 F_sr1
    s_branch F_sb1
F_sx1:
    s_mov_b32 s18, 0
    s_branch F_sb1
F_sr2:
    s_sub_u32 s18, s18, 1
    s_cbranch_scc1 F_sx2
    s_add_u32 m0, s25, 5120
    s_add_u32 s63, s5, 2
    s_and_b32 s63, s63, 15
    s_lshl_b32 s63, s63, 10
    s_xor_b32 s63, s63, s28
    buffer_load_dwordx4 v14, s[44:47], s63 offen offset:0 sc1 lds
    buffer_load_dwordx4 v15, s[44:47], s63 offen offset:1024 sc1 lds
    s_waitcnt vmcnt(0)
    ds_read_b64_tr_b16 v[40:41], v4 offset:5120
    ds_read_b64_tr_b16 v[42:43], v4 offset:5376
    ds_read_b64_tr_b16 v[44:45], v4 offset:6144
    ds_read_b64_tr_b16 v[46:47], v4 offset:6400
    ds_read_b64 v[48:49], v5 offset:5128
    ds_read_b64 v[50:51], v5 offset:6152
    s_waitcnt lgkmcnt(0)
    v_cmp_eq_u64 vcc, v[48:49], v[220:221]
    v_cmp_eq_u64 s[14:15], v[50:51], v[220:221]
    s_nop 0
    s_or_b64 vcc, vcc, s[14:15]
    s_cbranch_scc1 F_sr2
    s_branch F_sb2
F_sx2:
    s_mov_b32 s18, 0
    s_branch F_sb2
F_sr3:
    s_sub_u32 s18, s18, 1
    s_cbranch_scc1 F_sx3
    s_add_u32 m0, s25, 6656
    s_add_u32 s63, s5, 2
    s_and_b32 s63, s63, 15
    s_lshl_b32 s63, s63, 10
    s_xor_b32 s63, s63, s28
    buffer_load_dwordx4 v14, s[44:47], s63 offen offset:512 sc1 lds
    buffer_load_dwordx4 v15, s[44:47], s63 offen offset:1536 sc1 lds
    s_waitcnt vmcnt(0)
    ds_read_b64_tr_b16 v[52:53], v4 offset:7168
    ds_read_b64_tr_b16 v[54:55], v4 offset:7424
    ds_read_b64_tr_b16 v[56:57], v4 offset:8192
    ds_read_b64_tr_b16 v[58:59], v4 offset:8448
    ds_read_b64 v[60:61], v5 offset:7176
    ds_read_b64 v[62:63], v5 offset:8200
    s_waitcnt lgkmcnt(0)
    v_cmp_eq_u64 vcc, v[60:61], v[220:221]
    v_cmp_eq_u64 s[14:15], v[62:63], v[220:221]
    s_nop 0
    s_or_b64 vcc, vcc, s[14:15]
    s_cbranch_scc1 F_sr3
    s_branch F_sb3
F_sx3:
    s_mov_b32 s18, 0
    s_branch F_sb3
F_sr4:
    s_sub_u32 s18, s18, 1
    s_cbranch_scc1 F_sx4
    s_add_u32 m0, s25, 9216
    s_add_u32 s63, s5, 4
    s_and_b32 s63, s63, 15
    s_lshl_b32 s63, s63, 10
    s_xor_b32 s63, s63, s28
    buffer_load_dwordx4 v14, s[44:47], s63 offen offset:0 sc1 lds
    buffer_load_dwordx4 v15, s[44:47], s63 offen offset:1024 sc1 lds
    s_waitcnt vmcnt(0)
    ds_read_b64_tr_b16 v[40:41], v4 offset:9216
    ds_read_b64_tr_b16 v[42:43], v4 offset:9472
    ds_read_b64_tr_b16 v[44:45], v4 offset:10240
    ds_read_b64_tr_b16 v[46:47], v4 offset:10496
    ds_read_b64 v[48:49], v5 offset:9224
    ds_read_b64 v[50:51], v5 offset:10248
    s_waitcnt lgkmcnt(0)
    v_cmp_eq_u64 vcc, v[48:49], v[220:221]
    v_cmp_eq_u64 s[14:15], v[50:51], v[220:221]
    s_nop 0
    s_or_b64 vcc, vcc, s[14:15]
    s_cbranch_scc1 F_sr4
    s_branch F_sb4
F_sx4:
    s_mov_b32 s18, 0
    s_branch F_sb4
F_sr5:
    s_sub_u32 s18, s18, 1
    s_cbranch_scc1 F_sx5
    s_add_u32 m0, s25, 10752
    s_add_u32 s63, s5, 4
    s_and_b32 s63, s63, 15
    s_lshl_b32 s63, s63, 10
    s_xor_b32 s63, s63, s28
    buffer_load_dwordx4 v14, s[44:47], s63 offen offset:512 sc1 lds
    buffer_load_dwordx4 v15, s[44:47], s63 offen offset:1536 sc1 lds
    s_waitcnt vmcnt(0)
    ds_read_b64_tr_b16 v[52:53], v4 offset:11264
    ds_read_b64_tr_b16 v[54:55], v4 offset:11520
    ds_read_b64_tr_b16 v[56:57], v4 offset:12288
    ds_read_b64_tr_b16 v[58:59], v4 offset:12544
    ds_read_b64 v[60:61], v5 offset:11272
    ds_read_b64 v[62:63], v5 offset:12296
    s_waitcnt lgkmcnt(0)
    v_cmp_eq_u64 vcc, v[60:61], v[220:221]
    v_cmp_eq_u64 s[14:15], v[62:63], v[220:221]
    s_nop 0
    s_or_b64 vcc, vcc, s[14:15]
    s_cbranch_scc1 F_sr5
    s_branch F_sb5
F_sx5:
    s_mov_b32 s18, 0
    s_branch F_sb5
F_sr6:
    s_sub_u32 s18, s18, 1
    s_cbranch_scc1 F_sx6
    s_add_u32 m0, s25, 13312
    s_add_u32 s63, s5, 6
    s_and_b32 s63, s63, 15
    s_lshl_b32 s63, s63, 10
    s_xor_b32 s63, s63, s28
    buffer_load_dwordx4 v14, s[44:47], s63 offen offset:0 sc1 lds
    buffer_load_dwordx4 v15, s[44:47], s63 offen offset:1024 sc1 lds
    s_waitcnt vmcnt(0)
    ds_read_b64_tr_b16 v[40:41], v4 offset:13312
    ds_read_b64_tr_b16 v[42:43], v4 offset:13568
    ds_read_b64_tr_b16 v[44:45], v4 offset:14336
    ds_read_b64_tr_b16 v[46:47], v4 offset:14592
    ds_read_b64 v[48:49], v5 offset:13320
    ds_read_b64 v[50:51], v5 offset:14344
    s_waitcnt lgkmcnt(0)
    v_cmp_eq_u64 vcc, v[48:49], v[220:221]
    v_cmp_eq_u64 s[14:15], v[50:51], v[220:221]
    s_nop 0
    s_or_b64 vcc, vcc, s[14:15]
    s_cbranch_scc1 F_sr6
    s_branch F_sb6
F_sx6:
    s_mov_b32 s18, 0
    s_branch F_sb6
F_sr7:
    s_sub_u32 s18, s18, 1
    s_cbranch_scc1 F_sx7
    s_add_u32 m0, s25, 14848
    s_add_u32 s63, s5, 6
    s_and_b32 s63, s63, 15
    s_lshl_b32 s63, s63, 10
    s_xor_b32 s63, s63, s28
    buffer_load_dwordx4 v14, s[44:47], s63 offen offset:512 sc1 lds
    buffer_load_dwordx4 v15, s[44:47], s63 offen offset:1536 sc1 lds
    s_waitcnt vmcnt(0)
    ds_read_b64_tr_b16 v[52:53], v4 offset:15360
    ds_read_b64_tr_b16 v[54:55], v4 offset:15616
    ds_read_b64_tr_b16 v[56:57], v4 offset:16384
    ds_read_b64_tr_b16 v[58:59], v4 offset:16640
    ds_read_b64 v[60:61], v5 offset:15368
    ds_read_b64 v[62:63], v5 offset:16392
    s_waitcnt lgkmcnt(0)
    v_cmp_eq_u64 vcc, v[60:61], v[220:221]
    v_cmp_eq_u64 s[14:15], v[62:63], v[220:221]
    s_nop 0
    s_or_b64 vcc, vcc, s[14:15]
    s_cbranch_scc1 F_sr7
    s_branch F_sb7
F_sx7:
    s_mov_b32 s18, 0
    s_branch F_sb7
F_sr8:
    s_sub_u32 s18, s18, 1
    s_cbranch_scc1 F_sx8
    s_add_u32 m0, s25, 17408
    s_add_u32 s63, s5, 8
    s_and_b32 s63, s63, 15
    s_lshl_b32 s63, s63, 10
    s_xor_b32 s63, s63, s28
    buffer_load_dwordx4 v14, s[44:47], s63 offen offset:0 sc1 lds
    buffer_load_dwordx4 v15, s[44:47], s63 offen offset:1024 sc1 lds
    s_waitcnt vmcnt(0)
    ds_read_b64_tr_b16 v[40:41], v4 offset:17408
    ds_read_b64_tr_b16 v[42:43], v4 offset:17664
    ds_read_b64_tr_b16 v[44:45], v4 offset:18432
    ds_read_b64_tr_b16 v[46:47], v4 offset:18688
    ds_read_b64 v[48:49], v5 offset:17416
    ds_read_b64 v[50:51], v5 offset:18440
    s_waitcnt lgkmcnt(0)
    v_cmp_eq_u64 vcc, v[48:49], v[220:221]
    v_cmp_eq_u64 s[14:15], v[50:51], v[220:221]
    s_nop 0
    s_or_b64 vcc, vcc, s[14:15]
    s_cbranch_scc1 F_sr8
    s_branch F_sb8
F_sx8:
    s_mov_b32 s18, 0
    s_branch F_sb8
F_sr9:
    s_sub_u32 s18, s18, 1
    s_cbranch_scc1 F_sx9
    s_add_u32 m0, s25, 18944
    s_add_u32 s63, s5, 8
    s_and_b32 s63, s63, 15
    s_lshl_b32 s63, s63, 10
    s_xor_b32 s63, s63, s28
    buffer_load_dwordx4 v14, s[44:47], s63 offen offset:512 sc1 lds
    buffer_load_dwordx4 v15, s[44:47], s63 offen offset:1536 sc1 lds
    s_waitcnt vmcnt(0)
    ds_read_b64_tr_b16 v[52:53], v4 offset:19456
    ds_read_b64_tr_b16 v[54:55], v4 offset:19712
    ds_read_b64_tr_b16 v[56:57], v4 offset:20480
    ds_read_b64_tr_b16 v[58:59], v4 offset:20736
    ds_read_b64 v[60:61], v5 offset:19464
    ds_read_b64 v[62:63], v5 offset:20488
    s_waitcnt lgkmcnt(0)
    v_cmp_eq_u64 vcc, v[60:61], v[220:221]
    v_cmp_eq_u64 s[14:15], v[62:63], v[220:221]
    s_nop 0
    s_or_b64 vcc, vcc, s[14:15]
    s_cbranch_scc1 F_sr9
    s_branch F_sb9
F_sx9:
    s_mov_b32 s18, 0
    s_branch F_sb9
F_sr10:
    s_sub_u32 s18, s18, 1
    s_cbranch_scc1 F_sx10
    s_add_u32 m0, s25, 21504
    s_add_u32 s63, s5, 10
    s_and_b32 s63, s63, 15
    s_lshl_b32 s63, s63, 10
    s_xor_b32 s63, s63, s28
    buffer_load_dwordx4 v14, s[44:47], s63 offen offset:0 sc1 lds
    buffer_load_dwordx4 v15, s[44:47], s63 offen offset:1024 sc1 lds
    s_waitcnt vmcnt(0)
    ds_read_b64_tr_b16 v[40:41], v4 offset:21504
    ds_read_b64_tr_b16 v[42:43], v4 offset:21760
    ds_read_b64_tr_b16 v[44:45], v4 offset:22528
    ds_read_b64_tr_b16 v[46:47], v4 offset:22784
    ds_read_b64 v[48:49], v5 offset:21512
    ds_read_b64 v[50:51], v5 offset:22536
    s_waitcnt lgkmcnt(0)
    v_cmp_eq_u64 vcc, v[48:49], v[220:221]
    v_cmp_eq_u64 s[14:15], v[50:51], v[220:221]
    s_nop 0
    s_or_b64 vcc, vcc, s[14:15]
    s_cbranch_scc1 F_sr10
    s_branch F_sb10
F_sx10:
    s_mov_b32 s18, 0
    s_branch F_sb10
F_sr11:
    s_sub_u32 s18, s18, 1
    s_cbranch_scc1 F_sx11
    s_add_u32 m0, s25, 23040
    s_add_u32 s63, s5, 10
    s_and_b32 s63, s63, 15
    s_lshl_b32 s63, s63, 10
    s_xor_b32 s63, s63, s28
    buffer_load_dwordx4 v14, s[44:47], s63 offen offset:512 sc1 lds
    buffer_load_dwordx4 v15, s[44:47], s63 offen offset:1536 sc1 lds
    s_waitcnt vmcnt(0)
    ds_read_b64_tr_b16 v[52:53], v4 offset:23552
    ds_read_b64_tr_b16 v[54:55], v4 offset:23808
    ds_read_b64_tr_b16 v[56:57], v4 offset:24576
    ds_read_b64_tr_b16 v[58:59], v4 offset:24832
    ds_read_b64 v[60:61], v5 offset:23560
    ds_read_b64 v[62:63], v5 offset:24584
    s_waitcnt lgkmcnt(0)
    v_cmp_eq_u64 vcc, v[60:61], v[220:221]
    v_cmp_eq_u64 s[14:15], v[62:63], v[220:221]
    s_nop 0
    s_or_b64 vcc, vcc, s[14:15]
    s_cbranch_scc1 F_sr11
    s_branch F_sb11
F_sx11:
    s_mov_b32 s18, 0
    s_branch F_sb11
F_sr12:
    s_sub_u32 s18, s18, 1
    s_cbranch_scc1 F_sx12
    s_add_u32 m0, s25, 25600
    s_add_u32 s63, s5, 12
    s_and_b32 s63, s63, 15
    s_lshl_b32 s63, s63, 10
    s_xor_b32 s63, s63, s28
    buffer_load_dwordx4 v14, s[44:47], s63 offen offset:0 sc1 lds
    buffer_load_dwordx4 v15, s[44:47], s63 offen offset:1024 sc1 lds
    s_waitcnt vmcnt(0)
    ds_read_b64_tr_b16 v[40:41], v4 offset:25600
    ds_read_b64_tr_b16 v[42:43], v4 offset:25856
    ds_read_b64_tr_b16 v[44:45], v4 offset:26624
    ds_read_b64_tr_b16 v[46:47], v4 offset:26880
    ds_read_b64 v[48:49], v5 offset:25608
    ds_read_b64 v[50:51], v5 offset:26632
    s_waitcnt lgkmcnt(0)
    v_cmp_eq_u64 vcc, v[48:49], v[220:221]
    v_cmp_eq_u64 s[14:15], v[50:51], v[220:221]
    s_nop 0
    s_or_b64 vcc, vcc, s[14:15]
    s_cbranch_scc1 F_sr12
    s_branch F_sb12
F_sx12:
    s_mov_b32 s18, 0
    s_branch F_sb12
F_sr13:
    s_sub_u32 s18, s18, 1
    s_cbranch_scc1 F_sx13
    s_add_u32 m0, s25, 27136
    s_add_u32 s63, s5, 12
    s_and_b32 s63, s63, 15
    s_lshl_b32 s63, s63, 10
    s_xor_b32 s63, s63, s28
    buffer_load_dwordx4 v14, s[44:47], s63 offen offset:512 sc1 lds
    buffer_load_dwordx4 v15, s[44:47], s63 offen offset:1536 sc1 lds
    s_waitcnt vmcnt(0)
    ds_read_b64_tr_b16 v[52:53], v4 offset:27648
    ds_read_b64_tr_b16 v[54:55], v4 offset:27904
    ds_read_b64_tr_b16 v[56:57], v4 offset:28672
    ds_read_b64_tr_b16 v[58:59], v4 offset:28928
    ds_read_b64 v[60:61], v5 offset:27656
    ds_read_b64 v[62:63], v5 offset:28680
    s_waitcnt lgkmcnt(0)
    v_cmp_eq_u64 vcc, v[60:61], v[220:221]
    v_cmp_eq_u64 s[14:15], v[62:63], v[220:221]
    s_nop 0
    s_or_b64 vcc, vcc, s[14:15]
    s_cbranch_scc1 F_sr13
    s_branch F_sb13
F_sx13:
    s_mov_b32 s18, 0
    s_branch F_sb13
F_sr14:
    s_sub_u32 s18, s18, 1
    s_cbranch_scc1 F_sx14
    s_add_u32 m0, s25, 29696
    s_add_u32 s63, s5, 14
    s_and_b32 s63, s63, 15
    s_lshl_b32 s63, s63, 10
    s_xor_b32 s63, s63, s28
    buffer_load_dwordx4 v14, s[44:47], s63 offen offset:0 sc1 lds
    buffer_load_dwordx4 v15, s[44:47], s63 offen offset:1024 sc1 lds
    s_waitcnt vmcnt(0)
    ds_read_b64_tr_b16 v[40:41], v4 offset:29696
    ds_read_b64_tr_b16 v[42:43], v4 offset:29952
    ds_read_b64_tr_b16 v[44:45], v4 offset:30720
    ds_read_b64_tr_b16 v[46:47], v4 offset:30976
    ds_read_b64 v[48:49], v5 offset:29704
    ds_read_b64 v[50:51], v5 offset:30728
    s_waitcnt lgkmcnt(0)
    v_cmp_eq_u64 vcc, v[48:49], v[220:221]
    v_cmp_eq_u64 s[14:15], v[50:51], v[220:221]
    s_nop 0
    s_or_b64 vcc, vcc, s[14:15]
    s_cbranch_scc1 F_sr14
    s_branch F_sb14
F_sx14:
    s_mov_b32 s18, 0
    s_branch F_sb14
F_sr15:
    s_sub_u32 s18, s18, 1
    s_cbranch_scc1 F_sx15
    s_add_u32 m0, s25, 31232
    s_add_u32 s63, s5, 14
    s_and_b32 s63, s63, 15
    s_lshl_b32 s63, s63, 10
    s_xor_b32 s63, s63, s28
    buffer_load_dwordx4 v14, s[44:47], s63 offen offset:512 sc1 lds
    buffer_load_dwordx4 v15, s[44:47], s63 offen offset:1536 sc1 lds
    s_waitcnt vmcnt(0)
    ds_read_b64_tr_b16 v[52:53], v4 offset:31744
    ds_read_b64_tr_b16 v[54:55], v4 offset:32000
    ds_read_b64_tr_b16 v[56:57], v4 offset:32768
    ds_read_b64_tr_b16 v[58:59], v4 offset:33024
    ds_read_b64 v[60:61], v5 offset:31752
    ds_read_b64 v[62:63], v5 offset:32776
    s_waitcnt lgkmcnt(0)
    v_cmp_eq_u64 vcc, v[60:61], v[220:221]
    v_cmp_eq_u64 s[14:15], v[62:63], v[220:221]
    s_nop 0
    s_or_b64 vcc, vcc, s[14:15]
    s_cbranch_scc1 F_sr15
    s_branch F_sb15
F_sx15:
    s_mov_b32 s18, 0
    s_branch F_sb15
B_help:
    ds_write_b64 v213, v[196:197] offset:36864
    ds_write_b64 v213, v[198:199] offset:40960
    ds_write_b64 v213, v[200:201] offset:45056
    ds_write_b64 v213, v[202:203] offset:49152
    s_cmp_lg_u32 s19, 0
    s_cbranch_scc1 B_notok
    s_lshl_b32 s9, s2, 5
    s_add_u32 s9, s9, 65536
    s_mov_b64 exec, 1
    buffer_store_dwordx2 v[220:221], off, s[40:43], s9 sc1
    s_mov_b64 exec, -1
B_notok:
    s_cmp_lg_u32 s2, 0
    s_cbranch_scc1 B_noep
    s_mov_b32 s9, 20480
    buffer_store_dwordx2 v[220:221], off, s[40:43], s9
B_noep:
    s_add_u32 s64, s5, 1
    s_and_b32 s64, s64, 15
    s_add_u32 m0, s6, 114688
    s_mul_i32 s64, s64, 88064
    buffer_load_dwordx4 v240, s[48:51], s64 offen offset:0  lds
    buffer_load_dwordx4 v241, s[48:51], s64 offen offset:1024  lds
    buffer_load_dwordx4 v242, s[48:51], s64 offen offset:2048  lds
    s_add_u32 s64, s5, 2
    s_and_b32 s64, s64, 15
    s_add_u32 m0, s6, 126976
    s_mul_i32 s64, s64, 88064
    buffer_load_dwordx4 v240, s[48:51], s64 offen offset:0  lds
    buffer_load_dwordx4 v241, s[48:51], s64 offen offset:1024  lds
    buffer_load_dwordx4 v242, s[48:51], s64 offen offset:2048  lds
    s_load_dwordx2 s[10:11], s[0:1], 88
    s_waitcnt lgkmcnt(0)
    v_lshlrev_b32 v44, 5, v33
    v_add_u32 v44, 65536, v44
    s_barrier
    buffer_load_dwordx2 v[42:43], v44, s[40:43], 0 offen sc1
    s_barrier
    s_cmp_eq_u32 s16, 15
    s_cbranch_scc1 F_lstat
    s_add_u32 s64, s5, 3
    s_and_b32 s64, s64, 15
    s_add_u32 m0, s6, 139264
    s_mul_i32 s64, s64, 88064
    buffer_load_dwordx4 v240, s[48:51], s64 offen offset:0  lds
    buffer_load_dwordx4 v241, s[48:51], s64 offen offset:1024  lds
    buffer_load_dwordx4 v242, s[48:51], s64 offen offset:2048  lds
    s_mov_b32 s3, s17
    v_and_b32 v1, 63, v0
    v_lshlrev_b32 v2, 4, v1
    s_add_u32 s36, s30, 0x510000
    s_addc_u32 s37, s31, 0
    s_mov_b32 s38, 0x560000
    s_mov_b32 s39, 0x20000
    s_mov_b32 s20, s28
    s_mov_b32 s21, s29
    s_mov_b32 s22, 0x158000
    s_mov_b32 s23, 0x20000
    s_waitcnt lgkmcnt(0)
    s_mov_b32 s32, s10
    s_mov_b32 s33, s11
    s_mov_b32 s34, 0x200000
    s_mov_b32 s35, 0x20000
    s_lshl_b32 s24, s3, 2
    s_add_u32 s24, s24, s19
    s_lshl_b32 s25, s19, 11
    v_add_u32 v3, s25, v2
    v_add_u32 v3, 36864, v3
    v_add_u32 v4, 8, v3
    s_lshl_b32 s26, s19, 10
    s_lshr_b32 s8, s2, 6
    s_bfe_u32 s9, s2, 0x10001
    s_add_u32 s64, s5, 4
    s_and_b32 s64, s64, 15
    s_add_u32 m0, s6, 151552
    s_mul_i32 s64, s64, 88064
    buffer_load_dwordx4 v240, s[48:51], s64 offen offset:0  lds
    buffer_load_dwordx4 v241, s[48:51], s64 offen offset:1024  lds
    buffer_load_dwordx4 v242, s[48:51], s64 offen offset:2048  lds
    s_lshl_b32 s9, s9, 2
    s_add_u32 s8, s8, s9
    s_and_b32 s9, s2, 1
    s_xor_b32 s8, s8, 0
    s_lshl_b32 s9, s9, 1
    s_add_u32 s9, s9, s62
    s_lshl_b32 s12, s3, 2
    s_add_u32 s12, s12, s9
    s_lshl_b32 s13, s8, 7
    s_lshl_b32 s14, s62, 13
    s_add_u32 s14, s14, s13
    s_mul_i32 s15, s12, 88064
    s_mul_i32 s55, s61, 44032
    s_add_u32 s55, s55, s15
    s_mul_i32 s63, s61, 737280
    s_add_u32 s52, s63, s14
    s_mul_i32 s63, s61, 16384
    s_add_u32 s53, s63, s14
    s_mul_i32 s63, s61, 688128
    s_add_u32 s54, s63, s14
    s_lshl_b32 s58, s12, 15
    s_add_u32 s58, s58, s13
    s_lshl_b32 s63, s61, 6
    s_add_u32 s58, s58, s63
    s_lshl_b32 s27, s8, 1
    s_add_u32 s27, s27, s61
    s_sub_u32 s27, s27, s5
    s_and_b32 s27, s27, 15
    s_add_u32 s64, s5, 5
    s_and_b32 s64, s64, 15
    s_add_u32 m0, s6, 0
    s_mul_i32 s64, s64, 88064
    buffer_load_dwordx4 v240, s[48:51], s64 offen offset:0  lds
    buffer_load_dwordx4 v241, s[48:51], s64 offen offset:1024  lds
    buffer_load_dwordx4 v242, s[48:51], s64 offen offset:2048  lds
    v_lshrrev_b32 v6, 3, v1
    v_and_b32 v7, 7, v1
    v_bfe_u32 v8, v1, 4, 1
    v_lshlrev_b32 v9, 2, v8
    v_xor_b32 v7, v7, v9
    v_lshlrev_b32 v6, 10, v6
    v_lshl_add_u32 v6, v7, 4, v6
    v_lshrrev_b32 v12, 5, v1
    v_bfe_u32 v13, v1, 2, 2
    v_lshl_add_u32 v9, v12, 3, v13
    v_lshlrev_b32 v10, 7, v9
    v_lshrrev_b32 v9, 1, v13
    v_xor_b32 v9, s61, v9
    v_lshl_add_u32 v10, v9, 6, v10
    v_and_b32 v9, 1, v1
    v_bfe_u32 v11, v1, 1, 1
    v_lshl_add_u32 v11, v8, 1, v11
    v_lshl_add_u32 v9, v9, 2, v11
    v_lshl_add_u32 v10, v9, 3, v10
    v_lshl_add_u32 v176, s61, 11, v10
    v_xor_b32 v177, 64, v176
    v_add_u32 v178, 61440, v176
    v_add_u32 v179, 61440, v177
    v_add_u32 v180, 122880, v176
    v_add_u32 v181, 122880, v177
    v_lshl_add_u32 v9, v12, 4, v13
    s_add_u32 s64, s5, 6
    s_and_b32 s64, s64, 15
    s_add_u32 m0, s6, 12288
    s_mul_i32 s64, s64, 88064
    buffer_load_dwordx4 v240, s[48:51], s64 offen offset:0  lds
    buffer_load_dwordx4 v241, s[48:51], s64 offen offset:1024  lds
    buffer_load_dwordx4 v242, s[48:51], s64 offen offset:2048  lds
    v_lshlrev_b32 v9, 6, v9
    v_lshl_add_u32 v9, v8, 5, v9
    v_and_b32 v13, 3, v1
    v_lshl_add_u32 v9, v13, 3, v9
    v_lshl_add_u32 v9, s9, 11, v9
    v_add_u32 v9, 36864, v9
    v_and_b32 v13, 31, v1
    v_lshlrev_b32 v13, 10, v13
    v_lshl_add_u32 v12, v12, 5, v13
    s_mov_b32 s18, 262144
    s_mov_b32 s7, 262144
    v_and_b32 v14, 3, v1
    v_lshlrev_b32 v14, 4, v14
    v_bfe_u32 v15, v1, 2, 1
    v_mul_u32_u24 v15, 16640, v15
    v_add_u32 v14, v15, v14
    v_bfe_u32 v15, v1, 3, 1
    v_lshl_add_u32 v14, v15, 10, v14
    v_lshrrev_b32 v15, 4, v1
    v_lshl_add_u32 v14, v15, 6, v14
    s_and_b32 s28, s24, 7
    s_lshl_b32 s28, s28, 11
    s_mul_i32 s24, s24, 33280
    v_add_u32 v14, s24, v14
    v_add_u32 v15, 256, v14
    v_add_u32 v14, 1024, v14
    s_add_u32 s64, s5, 7
    s_and_b32 s64, s64, 15
    s_add_u32 m0, s6, 24576
    s_mul_i32 s64, s64, 88064
    buffer_load_dwordx4 v240, s[48:51], s64 offen offset:0  lds
    buffer_load_dwordx4 v241, s[48:51], s64 offen offset:1024  lds
    buffer_load_dwordx4 v242, s[48:51], s64 offen offset:2048  lds
    s_waitcnt vmcnt(15)
F_tka:
    v_cmp_ne_u64 vcc, v[42:43], v[220:221]
    s_cbranch_vccz F_tkoa
    s_mov_b64 exec, vcc
    buffer_load_dwordx2 v[42:43], v44, s[40:43], 0 offen sc1
    s_waitcnt vmcnt(0)
    s_sub_u32 s7, s7, 1
    s_cbranch_scc0 F_tka
    s_mov_b32 s7, 0
F_tkoa:
    s_mov_b64 exec, -1
    s_barrier
    s_add_u32 m0, s25, 36864
    s_add_u32 s24, s5, 0
    s_and_b32 s24, s24, 15
    s_lshl_b32 s24, s24, 10
    s_xor_b32 s29, s24, s28
    buffer_load_dwordx4 v14, s[44:47], s29 offen offset:0 sc1 lds
    buffer_load_dwordx4 v15, s[44:47], s29 offen offset:1024 sc1 lds
    s_add_u32 m0, s25, 44544
    s_nop 0
    buffer_load_dwordx4 v14, s[44:47], s29 offen offset:512 sc1 lds
    buffer_load_dwordx4 v15, s[44:47], s29 offen offset:1536 sc1 lds
    s_add_u32 s24, s24, 2048
    s_add_u32 m0, s25, 53248
    s_and_b32 s24, s24, 0x3fff
    s_xor_b32 s29, s24, s28
    buffer_load_dwordx4 v14, s[44:47], s29 offen offset:0 sc1 lds
    buffer_load_dwordx4 v15, s[44:47], s29 offen offset:1024 sc1 lds
    s_add_u32 m0, s25, 60928
    s_nop 0
    buffer_load_dwordx4 v14, s[44:47], s29 offen offset:512 sc1 lds
    buffer_load_dwordx4 v15, s[44:47], s29 offen offset:1536 sc1 lds
    s_add_u32 s24, s24, 2048
    s_waitcnt vmcnt(6)
    ds_read2st64_b32 v[224:225], v4 offset0:0 offset1:4
    s_waitcnt lgkmcnt(0)
    v_cmp_eq_u32 vcc, v224, v220
    v_cmp_eq_u32 s[14:15], v225, v220
    s_nop 0
    s_or_b64 vcc, vcc, s[14:15]
    s_cbranch_scc1 F_hra0
F_hba0:
    s_barrier
    s_waitcnt vmcnt(4)
    ds_read2st64_b32 v[228:229], v4 offset0:32 offset1:36
    s_cmp_eq_u32 s27, 0
    s_cbranch_scc1 F_rra0
F_nra0:
    s_add_u32 m0, s25, 69632
    s_and_b32 s24, s24, 0x3fff
    s_xor_b32 s29, s24, s28
    buffer_load_dwordx4 v14, s[44:47], s29 offen offset:0 sc1 lds
    buffer_load_dwordx4 v15, s[44:47], s29 offen offset:1024 sc1 lds
    s_waitcnt lgkmcnt(0)
    v_cmp_eq_u32 vcc, v228, v220
    v_cmp_eq_u32 s[14:15], v229, v220
    s_nop 0
    s_or_b64 vcc, vcc, s[14:15]
    s_cbranch_scc1 F_hra1
F_hba1:
    s_add_u32 m0, s25, 77312
    s_nop 0
    buffer_load_dwordx4 v14, s[44:47], s29 offen offset:512 sc1 lds
    buffer_load_dwordx4 v15, s[44:47], s29 offen offset:1536 sc1 lds
    s_add_u32 s24, s24, 2048
    s_barrier
    s_waitcnt vmcnt(6)
    ds_read2st64_b32 v[232:233], v4 offset0:64 offset1:68
    s_cmp_eq_u32 s27, 1
    s_cbranch_scc1 F_rra1
F_nra1:
    s_add_u32 m0, s25, 86016
    s_and_b32 s24, s24, 0x3fff
    s_xor_b32 s29, s24, s28
    buffer_load_dwordx4 v14, s[44:47], s29 offen offset:0 sc1 lds
    buffer_load_dwordx4 v15, s[44:47], s29 offen offset:1024 sc1 lds
    s_add_u32 m0, s25, 93696
    s_nop 0
    buffer_load_dwordx4 v14, s[44:47], s29 offen offset:512 sc1 lds
    buffer_load_dwordx4 v15, s[44:47], s29 offen offset:1536 sc1 lds
    s_add_u32 s24, s24, 2048
    s_waitcnt lgkmcnt(0)
    v_cmp_eq_u32 vcc, v232, v220
    v_cmp_eq_u32 s[14:15], v233, v220
    s_nop 0
    s_or_b64 vcc, vcc, s[14:15]
    s_cbranch_scc1 F_hra2
F_hba2:
    s_add_u32 s64, s5, 8
    s_and_b32 s64, s64, 15
    s_add_u32 m0, s6, 102400
    s_mul_i32 s64, s64, 88064
    buffer_load_dwordx4 v240, s[48:51], s64 offen offset:0  lds
    buffer_load_dwordx4 v241, s[48:51], s64 offen offset:1024  lds
    buffer_load_dwordx4 v242, s[48:51], s64 offen offset:2048  lds
    s_barrier
    s_waitcnt vmcnt(11)
    ds_read2st64_b32 v[236:237], v4 offset0:96 offset1:100
    s_cmp_eq_u32 s27, 2
    s_cbranch_scc1 F_rra2
F_nra2:
    s_add_u32 m0, s25, 36864
    s_and_b32 s24, s24, 0x3fff
    s_xor_b32 s29, s24, s28
    buffer_load_dwordx4 v14, s[44:47], s29 offen offset:0 sc1 lds
    buffer_load_dwordx4 v15, s[44:47], s29 offen offset:1024 sc1 lds
    s_add_u32 m0, s25, 44544
    s_nop 0
    buffer_load_dwordx4 v14, s[44:47], s29 offen offset:512 sc1 lds
    buffer_load_dwordx4 v15, s[44:47], s29 offen offset:1536 sc1 lds
    s_add_u32 s24, s24, 2048
    s_waitcnt lgkmcnt(0)
    v_cmp_eq_u32 vcc, v236, v220
    v_cmp_eq_u32 s[14:15], v237, v220
    s_nop 0
    s_or_b64 vcc, vcc, s[14:15]
    s_cbranch_scc1 F_hra3
F_hba3:
    s_add_u32 s64, s5, 9
    s_and_b32 s64, s64, 15
    s_add_u32 m0, s6, 114688
    s_mul_i32 s64, s64, 88064
    buffer_load_dwordx4 v240, s[48:51], s64 offen offset:0  lds
    buffer_load_dwordx4 v241, s[48:51], s64 offen offset:1024  lds
    buffer_load_dwordx4 v242, s[48:51], s64 offen offset:2048  lds
    s_barrier
    s_waitcnt vmcnt(16)
    ds_read2st64_b32 v[224:225], v4 offset0:128 offset1:132
    s_cmp_eq_u32 s27, 3
    s_cbranch_scc1 F_rra3
F_nra3:
    s_add_u32 m0, s25, 53248
    s_and_b32 s24, s24, 0x3fff
    s_xor_b32 s29, s24, s28
    buffer_load_dwordx4 v14, s[44:47], s29 offen offset:0 sc1 lds
    buffer_load_dwordx4 v15, s[44:47], s29 offen offset:1024 sc1 lds
    s_waitcnt lgkmcnt(0)
    v_cmp_eq_u32 vcc, v224, v220
    v_cmp_eq_u32 s[14:15], v225, v220
    s_nop 0
    s_or_b64 vcc, vcc, s[14:15]
    s_cbranch_scc1 F_hra4
F_hba4:
    s_add_u32 s64, s5, 10
    s_and_b32 s64, s64, 15
    s_add_u32 m0, s6, 126976
    s_mul_i32 s64, s64, 88064
    buffer_load_dwordx4 v240, s[48:51], s64 offen offset:0  lds
    buffer_load_dwordx4 v241, s[48:51], s64 offen offset:1024  lds
    buffer_load_dwordx4 v242, s[48:51], s64 offen offset:2048  lds
    s_barrier
    s_waitcnt vmcnt(19)
    ds_read2st64_b32 v[228:229], v4 offset0:160 offset1:164
    s_cmp_eq_u32 s27, 4
    s_cbranch_scc1 F_rra4
F_nra4:
    s_add_u32 m0, s25, 60928
    s_nop 0
    buffer_load_dwordx4 v14, s[44:47], s29 offen offset:512 sc1 lds
    buffer_load_dwordx4 v15, s[44:47], s29 offen offset:1536 sc1 lds
    s_add_u32 s24, s24, 2048
    s_waitcnt lgkmcnt(0)
    v_cmp_eq_u32 vcc, v228, v220
    v_cmp_eq_u32 s[14:15], v229, v220
    s_nop 0
    s_or_b64 vcc, vcc, s[14:15]
    s_cbranch_scc1 F_hra5
F_hba5:
    s_add_u32 s64, s5, 11
    s_and_b32 s64, s64, 15
    s_add_u32 m0, s6, 139264
    s_mul_i32 s64, s64, 88064
    buffer_load_dwordx4 v240, s[48:51], s64 offen offset:0  lds
    buffer_load_dwordx4 v241, s[48:51], s64 offen offset:1024  lds
    buffer_load_dwordx4 v242, s[48:51], s64 offen offset:2048  lds
    s_barrier
    s_waitcnt vmcnt(22)
    ds_read2st64_b32 v[232:233], v4 offset0:192 offset1:196
    s_cmp_eq_u32 s27, 5
    s_cbranch_scc1 F_rra5
F_nra5:
    s_add_u32 m0, s25, 69632
    s_and_b32 s24, s24, 0x3fff
    s_xor_b32 s29, s24, s28
    buffer_load_dwordx4 v14, s[44:47], s29 offen offset:0 sc1 lds
    buffer_load_dwordx4 v15, s[44:47], s29 offen offset:1024 sc1 lds
    s_waitcnt lgkmcnt(0)
    v_cmp_eq_u32 vcc, v232, v220
    v_cmp_eq_u32 s[14:15], v233, v220
    s_nop 0
    s_or_b64 vcc, vcc, s[14:15]
    s_cbranch_scc1 F_hra6
F_hba6:
    s_add_u32 s64, s5, 12
    s_and_b32 s64, s64, 15
    s_add_u32 m0, s6, 151552
    s_mul_i32 s64, s64, 88064
    buffer_load_dwordx4 v240, s[48:51], s64 offen offset:0  lds
    buffer_load_dwordx4 v241, s[48:51], s64 offen offset:1024  lds
    buffer_load_dwordx4 v242, s[48:51], s64 offen offset:2048  lds
    s_barrier
    s_waitcnt vmcnt(25)
    ds_read2st64_b32 v[236:237], v4 offset0:224 offset1:228
    s_cmp_eq_u32 s27, 6
    s_cbranch_scc1 F_rra6
F_nra6:
    s_add_u32 m0, s25, 77312
    s_nop 0
    buffer_load_dwordx4 v14, s[44:47], s29 offen offset:512 sc1 lds
    buffer_load_dwordx4 v15, s[44:47], s29 offen offset:1536 sc1 lds
    s_add_u32 s24, s24, 2048
    s_waitcnt lgkmcnt(0)
    v_cmp_eq_u32 vcc, v236, v220
    v_cmp_eq_u32 s[14:15], v237, v220
    s_nop 0
    s_or_b64 vcc, vcc, s[14:15]
    s_cbranch_scc1 F_hra7
F_hba7:
    s_add_u32 s64, s5, 13
    s_and_b32 s64, s64, 15
    s_add_u32 m0, s6, 0
    s_mul_i32 s64, s64, 88064
    buffer_load_dwordx4 v240, s[48:51], s64 offen offset:0  lds
    buffer_load_dwordx4 v241, s[48:51], s64 offen offset:1024  lds
    buffer_load_dwordx4 v242, s[48:51], s64 offen offset:2048  lds
    s_barrier
    s_waitcnt vmcnt(25)
    ds_read2st64_b32 v[224:225], v4 offset0:0 offset1:4
    s_cmp_eq_u32 s27, 7
    s_cbranch_scc1 F_rra7
F_nra7:
    s_add_u32 m0, s25, 86016
    s_and_b32 s24, s24, 0x3fff
    s_xor_b32 s29, s24, s28
    buffer_load_dwordx4 v14, s[44:47], s29 offen offset:0 sc1 lds
    buffer_load_dwordx4 v15, s[44:47], s29 offen offset:1024 sc1 lds
    s_waitcnt lgkmcnt(0)
    v_cmp_eq_u32 vcc, v224, v220
    v_cmp_eq_u32 s[14:15], v225, v220
    s_nop 0
    s_or_b64 vcc, vcc, s[14:15]
    s_cbranch_scc1 F_hra8
F_hba8:
    s_add_u32 s64, s5, 14
    s_and_b32 s64, s64, 15
    s_add_u32 m0, s6, 12288
    s_mul_i32 s64, s64, 88064
    buffer_load_dwordx4 v240, s[48:51], s64 offen offset:0  lds
    buffer_load_dwordx4 v241, s[48:51], s64 offen offset:1024  lds
    buffer_load_dwordx4 v242, s[48:51], s64 offen offset:2048  lds
    s_waitcnt vmcnt(32)
    s_barrier
    s_waitcnt vmcnt(28)
    ds_read2st64_b32 v[228:229], v4 offset0:32 offset1:36
    s_cmp_eq_u32 s27, 8
    s_cbranch_scc1 F_rra8
F_nra8:
    s_add_u32 m0, s25, 93696
    s_nop 0
    buffer_load_dwordx4 v14, s[44:47], s29 offen offset:512 sc1 lds
    buffer_load_dwordx4 v15, s[44:47], s29 offen offset:1536 sc1 lds
    s_add_u32 s24, s24, 2048
    s_waitcnt lgkmcnt(0)
    v_cmp_eq_u32 vcc, v228, v220
    v_cmp_eq_u32 s[14:15], v229, v220
    s_nop 0
    s_or_b64 vcc, vcc, s[14:15]
    s_cbranch_scc1 F_hra9
F_hba9:
    s_add_u32 s64, s5, 15
    s_and_b32 s64, s64, 15
    s_add_u32 m0, s6, 24576
    s_mul_i32 s64, s64, 88064
    buffer_load_dwordx4 v240, s[48:51], s64 offen offset:0  lds
    buffer_load_dwordx4 v241, s[48:51], s64 offen offset:1024  lds
    buffer_load_dwordx4 v242, s[48:51], s64 offen offset:2048  lds
    s_waitcnt vmcnt(30)
    s_barrier
    s_waitcnt vmcnt(28)
    ds_read2st64_b32 v[232:233], v4 offset0:64 offset1:68
    s_cmp_eq_u32 s27, 9
    s_cbranch_scc1 F_rra9
F_nra9:
    s_add_u32 m0, s26, 102400
    s_add_u32 s63, s52, 0
    buffer_load_dwordx4 v6, s[20:23], s63 offen lds
    s_add_u32 m0, s26, 106496
    s_add_u32 s63, s52, 49152
    buffer_load_dwordx4 v6, s[20:23], s63 offen lds
    s_add_u32 m0, s26, 110592
    s_add_u32 s63, s52, 98304
    buffer_load_dwordx4 v6, s[20:23], s63 offen lds
    s_waitcnt lgkmcnt(0)
    v_cmp_eq_u32 vcc, v232, v220
    v_cmp_eq_u32 s[14:15], v233, v220
    s_nop 0
    s_or_b64 vcc, vcc, s[14:15]
    s_cbranch_scc1 F_hra10
F_hba10:
    s_add_u32 m0, s26, 36864
    s_add_u32 s63, s52, 147456
    buffer_load_dwordx4 v6, s[20:23], s63 offen lds
    s_add_u32 m0, s26, 40960
    s_add_u32 s63, s52, 196608
    buffer_load_dwordx4 v6, s[20:23], s63 offen lds
    s_waitcnt vmcnt(30)
    s_barrier
    s_waitcnt vmcnt(28)
    ds_read2st64_b32 v[236:237], v4 offset0:96 offset1:100
    s_cmp_eq_u32 s27, 10
    s_cbranch_scc1 F_rra10
F_nra10:
    s_add_u32 m0, s26, 45056
    s_add_u32 s63, s52, 245760
    buffer_load_dwordx4 v6, s[20:23], s63 offen lds
    s_add_u32 m0, s26, 49152
    s_add_u32 s63, s52, 294912
    buffer_load_dwordx4 v6, s[20:23], s63 offen lds
    s_add_u32 m0, s26, 114688
    s_add_u32 s63, s52, 344064
    buffer_load_dwordx4 v6, s[20:23], s63 offen lds
    s_waitcnt lgkmcnt(0)
    v_cmp_eq_u32 vcc, v236, v220
    v_cmp_eq_u32 s[14:15], v237, v220
    s_nop 0
    s_or_b64 vcc, vcc, s[14:15]
    s_cbranch_scc1 F_hra11
F_hba11:
    s_add_u32 m0, s26, 118784
    s_add_u32 s63, s52, 393216
    buffer_load_dwordx4 v6, s[20:23], s63 offen lds
    s_add_u32 m0, s26, 122880
    s_add_u32 s63, s52, 442368
    buffer_load_dwordx4 v6, s[20:23], s63 offen lds
    s_waitcnt vmcnt(30)
    s_barrier
    s_waitcnt vmcnt(28)
    ds_read2st64_b32 v[224:225], v4 offset0:128 offset1:132
    s_cmp_eq_u32 s27, 11
    s_cbranch_scc1 F_rra11
F_nra11:
    s_add_u32 m0, s26, 53248
    s_add_u32 s63, s52, 491520
    buffer_load_dwordx4 v6, s[20:23], s63 offen lds
    s_add_u32 m0, s26, 57344
    s_add_u32 s63, s52, 540672
    buffer_load_dwordx4 v6, s[20:23], s63 offen lds
    s_add_u32 m0, s26, 126976
    s_add_u32 s63, s52, 589824
    buffer_load_dwordx4 v6, s[20:23], s63 offen lds
    s_waitcnt lgkmcnt(0)
    v_cmp_eq_u32 vcc, v224, v220
    v_cmp_eq_u32 s[14:15], v225, v220
    s_nop 0
    s_or_b64 vcc, vcc, s[14:15]
    s_cbranch_scc1 F_hra12
F_hba12:
    s_add_u32 m0, s26, 131072
    s_add_u32 s63, s52, 638976
    buffer_load_dwordx4 v6, s[20:23], s63 offen lds
    s_add_u32 m0, s26, 135168
    s_add_u32 s63, s53, 688128
    buffer_load_dwordx4 v6, s[20:23], s63 offen lds
    s_waitcnt vmcnt(12)
    s_waitcnt vmcnt(30)
    s_barrier
    s_waitcnt vmcnt(28)
    ds_read2st64_b32 v[228:229], v4 offset0:160 offset1:164
    s_cmp_eq_u32 s27, 12
    s_cbranch_scc1 F_rra12
F_nra12:
    ds_read_b64_tr_b16 v[16:17], v178 offset:40960
    ds_read_b64_tr_b16 v[18:19], v178 offset:41472
    ds_read_b64_tr_b16 v[20:21], v179 offset:40960
    ds_read_b64_tr_b16 v[22:23], v179 offset:41472
    ds_read_b64_tr_b16 v[24:25], v178 offset:45056
    ds_read_b64_tr_b16 v[26:27], v178 offset:45568
    ds_read_b64_tr_b16 v[28:29], v179 offset:45056
    ds_read_b64_tr_b16 v[30:31], v179 offset:45568
    ds_read_b64_tr_b16 v[32:33], v178 offset:49152
    ds_read_b64_tr_b16 v[34:35], v178 offset:49664
    ds_read_b64_tr_b16 v[36:37], v179 offset:49152
    ds_read_b64_tr_b16 v[38:39], v179 offset:49664
    s_add_u32 m0, s26, 61440
    s_add_u32 s63, s52, 16384
    buffer_load_dwordx4 v6, s[20:23], s63 offen lds
    s_add_u32 m0, s26, 65536
    s_add_u32 s63, s52, 65536
    buffer_load_dwordx4 v6, s[20:23], s63 offen lds
    s_add_u32 m0, s26, 139264
    s_add_u32 s63, s52, 114688
    buffer_load_dwordx4 v6, s[20:23], s63 offen lds
    s_waitcnt lgkmcnt(0)
    v_cmp_eq_u32 vcc, v228, v220
    v_cmp_eq_u32 s[14:15], v229, v220
    s_nop 0
    s_or_b64 vcc, vcc, s[14:15]
    s_cbranch_scc1 F_hra13
F_hba13:
    s_add_u32 m0, s26, 143360
    s_add_u32 s63, s52, 163840
    buffer_load_dwordx4 v6, s[20:23], s63 offen lds
    s_add_u32 m0, s26, 147456
    s_add_u32 s63, s52, 212992
    buffer_load_dwordx4 v6, s[20:23], s63 offen lds
    s_waitcnt vmcnt(30)
    s_barrier
    s_waitcnt vmcnt(28)
    ds_read2st64_b32 v[232:233], v4 offset0:192 offset1:196
    s_cmp_eq_u32 s27, 13
    s_cbranch_scc1 F_rra13
F_nra13:
    s_add_u32 m0, s26, 69632
    s_add_u32 s63, s52, 262144
    buffer_load_dwordx4 v6, s[20:23], s63 offen lds
    s_add_u32 m0, s26, 73728
    s_add_u32 s63, s52, 311296
    buffer_load_dwordx4 v6, s[20:23], s63 offen lds
    s_add_u32 m0, s26, 151552
    s_add_u32 s63, s52, 360448
    buffer_load_dwordx4 v6, s[20:23], s63 offen lds
    s_add_u32 m0, s26, 155648
    s_add_u32 s63, s52, 409600
    buffer_load_dwordx4 v6, s[20:23], s63 offen lds
    s_waitcnt lgkmcnt(0)
    v_cmp_eq_u32 vcc, v232, v220
    v_cmp_eq_u32 s[14:15], v233, v220
    s_nop 0
    s_or_b64 vcc, vcc, s[14:15]
    s_cbranch_scc1 F_hra14
F_hba14:
    s_add_u32 m0, s26, 159744
    s_add_u32 s63, s52, 458752
    buffer_load_dwordx4 v6, s[20:23], s63 offen lds
    s_add_u32 m0, s26, 102400
    s_add_u32 s63, s52, 507904
    buffer_load_dwordx4 v6, s[20:23], s63 offen lds
    s_add_u32 m0, s26, 106496
    s_add_u32 s63, s52, 557056
    buffer_load_dwordx4 v6, s[20:23], s63 offen lds
    s_add_u32 m0, s26, 110592
    s_add_u32 s63, s52, 606208
    buffer_load_dwordx4 v6, s[20:23], s63 offen lds
    s_waitcnt vmcnt(33)
    s_barrier
    s_waitcnt vmcnt(31)
    ds_read2st64_b32 v[236:237], v4 offset0:224 offset1:228
    s_cmp_eq_u32 s27, 14
    s_cbranch_scc1 F_rra14
F_nra14:
    s_add_u32 m0, s26, 77824
    s_add_u32 s63, s52, 655360
    buffer_load_dwordx4 v6, s[20:23], s63 offen lds
    s_add_u32 m0, s26, 81920
    s_add_u32 s63, s54, 32768
    buffer_load_dwordx4 v6, s[20:23], s63 offen lds
    s_add_u32 m0, s26, 0
    s_add_u32 s63, s54, 81920
    buffer_load_dwordx4 v6, s[20:23], s63 offen lds
    s_waitcnt lgkmcnt(0)
    v_cmp_eq_u32 vcc, v236, v220
    v_cmp_eq_u32 s[14:15], v237, v220
    s_nop 0
    s_or_b64 vcc, vcc, s[14:15]
    s_cbranch_scc1 F_hra15
F_hba15:
    s_add_u32 m0, s26, 4096
    s_add_u32 s63, s54, 131072
    buffer_load_dwordx4 v6, s[20:23], s63 offen lds
    s_add_u32 m0, s26, 8192
    s_add_u32 s63, s54, 180224
    buffer_load_dwordx4 v6, s[20:23], s63 offen lds
    s_waitcnt vmcnt(33)
    s_barrier
    s_cmp_eq_u32 s27, 15
    s_cbranch_scc1 F_rra15
F_nra15:
    s_add_u32 m0, s26, 86016
    s_add_u32 s63, s54, 229376
    buffer_load_dwordx4 v6, s[20:23], s63 offen lds
    s_add_u32 m0, s26, 90112
    s_add_u32 s63, s54, 278528
    buffer_load_dwordx4 v6, s[20:23], s63 offen lds
    s_add_u32 m0, s26, 12288
    s_add_u32 s63, s54, 327680
    buffer_load_dwordx4 v6, s[20:23], s63 offen lds
    s_waitcnt lgkmcnt(0)
    s_add_u32 m0, s26, 16384
    s_add_u32 s63, s54, 376832
    buffer_load_dwordx4 v6, s[20:23], s63 offen lds
    s_add_u32 m0, s26, 20480
    s_add_u32 s63, s54, 425984
    buffer_load_dwordx4 v6, s[20:23], s63 offen lds
    s_barrier
    s_cmp_lg_u32 s19, 0
    s_cselect_b32 s64, 0x7fff0000, 0
    s_lshl_b32 s63, s3, 4
    s_add_u32 s63, s63, s16
    s_lshl_b32 s63, s63, 7
    s_add_u32 s63, s63, s64
    s_add_u32 s63, s63, 32768
    s_mov_b64 exec, 1
    buffer_store_dwordx2 v[220:221], off, s[40:43], s63 sc1
    s_mov_b64 exec, -1
    s_add_u32 m0, s26, 94208
    s_add_u32 s63, s54, 475136
    buffer_load_dwordx4 v6, s[20:23], s63 offen lds
    s_add_u32 m0, s26, 98304
    s_add_u32 s63, s54, 524288
    buffer_load_dwordx4 v6, s[20:23], s63 offen lds
    s_add_u32 m0, s26, 24576
    s_add_u32 s63, s54, 573440
    buffer_load_dwordx4 v6, s[20:23], s63 offen lds
    s_add_u32 m0, s26, 28672
    s_add_u32 s63, s54, 622592
    buffer_load_dwordx4 v6, s[20:23], s63 offen lds
    s_add_u32 m0, s26, 32768
    s_add_u32 s63, s54, 671744
    buffer_load_dwordx4 v6, s[20:23], s63 offen lds
F_g2:
    v_and_b32 v204, 31, v1
    v_lshrrev_b32 v203, 5, v1
    v_lshlrev_b32 v203, 1, v203
    v_lshrrev_b32 v202, 1, v204
    v_xor_b32 v203, v203, v202
    v_and_b32 v203, 3, v203
    v_lshlrev_b32 v204, 6, v204
    v_lshl_add_u32 v204, s19, 11, v204
    v_lshl_add_u32 v200, v203, 4, v204
    v_xor_b32 v201, 16, v200
    v_lshl_add_u32 v202, s19, 11, v2
    v_lshrrev_b32 v204, 3, v1
    v_xor_b32 v204, v204, v1
    v_and_b32 v204, 3, v204
    v_lshrrev_b32 v203, 2, v1
    v_lshlrev_b32 v203, 10, v203
    v_lshl_add_u32 v203, v204, 4, v203
    s_lshl_b32 s63, s19, 12
    v_add_u32 v14, s63, v2
    v_xor_b32 v15, 8192, v14
    v_add_u32 v14, 36864, v14
    v_add_u32 v15, 36864, v15
    v_add_u32 v200, 36864, v200
    v_add_u32 v201, 36864, v201
    v_add_u32 v202, 36864, v202
    v_lshlrev_b32 v64, 16, v40
    v_and_b32 v65, 0xffff0000, v40
    v_lshlrev_b32 v66, 16, v41
    v_and_b32 v67, 0xffff0000, v41
    v_lshlrev_b32 v68, 16, v42
    v_and_b32 v69, 0xffff0000, v42
    v_lshlrev_b32 v70, 16, v43
    v_and_b32 v71, 0xffff0000, v43
    v_lshlrev_b32 v72, 16, v44
    v_and_b32 v73, 0xffff0000, v44
    v_lshlrev_b32 v74, 16, v45
    v_and_b32 v75, 0xffff0000, v45
    v_lshlrev_b32 v76, 16, v46
    v_and_b32 v77, 0xffff0000, v46
    v_lshlrev_b32 v78, 16, v47
    v_and_b32 v79, 0xffff0000, v47
    s_cmp_lg_u32 s19, 0
    s_cbranch_scc1 F_hgo
    s_lshl_b32 s63, s3, 11
    s_add_u32 s56, s30, s63
    s_addc_u32 s57, s31, 0
    v_readfirstlane_b32 s63, v220
F_hwait:
    s_load_dword s8, s[56:57], 32768 glc
    s_load_dword s9, s[56:57], 32896 glc
    s_load_dword s10, s[56:57], 33024 glc
    s_load_dword s11, s[56:57], 33152 glc
    s_load_dword s12, s[56:57], 33280 glc
    s_load_dword s13, s[56:57], 33408 glc
    s_load_dword s14, s[56:57], 33536 glc
    s_load_dword s15, s[56:57], 33664 glc
    s_load_dword s48, s[56:57], 33792 glc
    s_load_dword s49, s[56:57], 33920 glc
    s_load_dword s50, s[56:57], 34048 glc
    s_load_dword s51, s[56:57], 34176 glc
    s_load_dword s52, s[56:57], 34304 glc
    s_load_dword s53, s[56:57], 34432 glc
    s_load_dword s54, s[56:57], 34560 glc
    s_waitcnt lgkmcnt(0)
    s_xor_b32 s8, s8, s63
    s_xor_b32 s9, s9, s63
    s_xor_b32 s10, s10, s63
    s_xor_b32 s11, s11, s63
    s_xor_b32 s12, s12, s63
    s_xor_b32 s13, s13, s63
    s_xor_b32 s14, s14, s63
    s_xor_b32 s15, s15, s63
    s_xor_b32 s48, s48, s63
    s_xor_b32 s49, s49, s63
    s_xor_b32 s50, s50, s63
    s_xor_b32 s51, s51, s63
    s_xor_b32 s52, s52, s63
    s_xor_b32 s53, s53, s63
    s_xor_b32 s54, s54, s63
    s_or_b32 s8, s8, s9
    s_or_b32 s8, s8, s10
    s_or_b32 s8, s8, s11
    s_or_b32 s8, s8, s12
    s_or_b32 s8, s8, s13
    s_or_b32 s8, s8, s14
    s_or_b32 s8, s8, s15
    s_or_b32 s8, s8, s48
    s_or_b32 s8, s8, s49
    s_or_b32 s8, s8, s50
    s_or_b32 s8, s8, s51
    s_or_b32 s8, s8, s52
    s_or_b32 s8, s8, s53
    s_or_b32 s8, s8, s54
    s_cbranch_scc0 F_hgo
    s_sub_u32 s7, s7, 1
    s_cbranch_scc0 F_hwait
F_hgo:
    s_barrier
    s_add_u32 s56, s55, 0
    buffer_load_dwordx4 v[96:99], v2, s[36:39], s56 offen offset:0 sc1
    buffer_load_dwordx4 v[100:103], v2, s[36:39], s56 offen offset:1024 sc1
    buffer_load_dwordx4 v[104:107], v2, s[36:39], s56 offen offset:2048 sc1
    buffer_load_dwordx4 v[108:111], v2, s[36:39], s56 offen offset:3072 sc1
    s_add_u32 s56, s55, 4096
    buffer_load_dwordx4 v[112:115], v2, s[36:39], s56 offen offset:0 sc1
    buffer_load_dwordx4 v[116:119], v2, s[36:39], s56 offen offset:1024 sc1
    buffer_load_dwordx4 v[120:123], v2, s[36:39], s56 offen offset:2048 sc1
    buffer_load_dwordx4 v[124:127], v2, s[36:39], s56 offen offset:3072 sc1
    s_add_u32 s56, s55, 8192
    buffer_load_dwordx4 v[128:131], v2, s[36:39], s56 offen offset:0 sc1
    buffer_load_dwordx4 v[132:135], v2, s[36:39], s56 offen offset:1024 sc1
    s_waitcnt vmcnt(9)
    v_cmp_eq_u32 vcc, -1, v98
    s_cbranch_vccnz F_gr0
F_gb0:
    s_barrier
    v_mfma_f32_32x32x16_bf16 v[64:79], v[16:19], v[96:99], v[64:79]
    s_waitcnt vmcnt(8)
    v_cmp_eq_u32 vcc, -1, v102
    ds_read_b64_tr_b16 v[168:169], v176 offset:36864
    ds_read_b64_tr_b16 v[170:171], v176 offset:37376
    v_mfma_f32_32x32x16_bf16 v[80:95], v[20:23], v[96:99], 0
    buffer_load_dwordx4 v[136:139], v2, s[36:39], s56 offen offset:2048 sc1
    ds_read_b64_tr_b16 v[172:173], v177 offset:36864
    ds_read_b64_tr_b16 v[174:175], v177 offset:37376
    s_cbranch_vccnz F_gr1
F_gb1:
    v_mfma_f32_32x32x16_bf16 v[64:79], v[24:27], v[100:103], v[64:79]
    s_waitcnt vmcnt(8)
    v_cmp_eq_u32 vcc, -1, v106
    ds_read_b64_tr_b16 v[48:49], v176 offset:40960
    ds_read_b64_tr_b16 v[50:51], v176 offset:41472
    v_mfma_f32_32x32x16_bf16 v[80:95], v[28:31], v[100:103], v[80:95]
    buffer_load_dwordx4 v[140:143], v2, s[36:39], s56 offen offset:3072 sc1
    ds_read_b64_tr_b16 v[52:53], v177 offset:40960
    ds_read_b64_tr_b16 v[54:55], v177 offset:41472
    s_cbranch_vccnz F_gr2
F_gb2:
    v_mfma_f32_32x32x16_bf16 v[64:79], v[32:35], v[104:107], v[64:79]
    s_waitcnt vmcnt(8) lgkmcnt(4)
    v_cmp_eq_u32 vcc, -1, v110
    ds_read_b64_tr_b16 v[56:57], v176 offset:45056
    ds_read_b64_tr_b16 v[58:59], v176 offset:45568
    s_add_u32 s56, s55, 12288
    v_mfma_f32_32x32x16_bf16 v[80:95], v[36:39], v[104:107], v[80:95]
    buffer_load_dwordx4 v[144:147], v2, s[36:39], s56 offen offset:0 sc1
    ds_read_b64_tr_b16 v[60:61], v177 offset:45056
    ds_read_b64_tr_b16 v[62:63], v177 offset:45568
    s_cbranch_vccnz F_gr3
F_gb3:
    v_mfma_f32_32x32x16_bf16 v[64:79], v[168:171], v[108:111], v[64:79]
    s_waitcnt vmcnt(8) lgkmcnt(4)
    v_cmp_eq_u32 vcc, -1, v114
    ds_read_b64_tr_b16 v[160:161], v176 offset:49152
    ds_read_b64_tr_b16 v[162:163], v176 offset:49664
    v_mfma_f32_32x32x16_bf16 v[80:95], v[172:175], v[108:111], v[80:95]
    buffer_load_dwordx4 v[148:151], v2, s[36:39], s56 offen offset:1024 sc1
    ds_read_b64_tr_b16 v[164:165], v177 offset:49152
    ds_read_b64_tr_b16 v[166:167], v177 offset:49664
    s_cbranch_vccnz F_gr4
F_gb4:
    v_mfma_f32_32x32x16_bf16 v[64:79], v[48:51], v[112:115], v[64:79]
    s_waitcnt vmcnt(8) lgkmcnt(4)
    v_cmp_eq_u32 vcc, -1, v118
    ds_read_b64_tr_b16 v[168:169], v178 offset:53248
    ds_read_b64_tr_b16 v[170:171], v178 offset:53760
    v_mfma_f32_32x32x16_bf16 v[80:95], v[52:55], v[112:115], v[80:95]
    buffer_load_dwordx4 v[152:155], v2, s[36:39], s56 offen offset:2048 sc1
    ds_read_b64_tr_b16 v[172:173], v179 offset:53248
    ds_read_b64_tr_b16 v[174:175], v179 offset:53760
    s_cbranch_vccnz F_gr5
F_gb5:
    v_mfma_f32_32x32x16_bf16 v[64:79], v[56:59], v[116:119], v[64:79]
    s_waitcnt vmcnt(8) lgkmcnt(4)
    v_cmp_eq_u32 vcc, -1, v122
    ds_read_b64_tr_b16 v[48:49], v178 offset:57344
    ds_read_b64_tr_b16 v[50:51], v178 offset:57856
    v_mfma_f32_32x32x16_bf16 v[80:95], v[60:63], v[116:119], v[80:95]
    buffer_load_dwordx4 v[156:159], v2, s[36:39], s56 offen offset:3072 sc1
    ds_read_b64_tr_b16 v[52:53], v179 offset:57344
    ds_read_b64_tr_b16 v[54:55], v179 offset:57856
    s_cbranch_vccnz F_gr6
F_gb6:
    v_mfma_f32_32x32x16_bf16 v[64:79], v[160:163], v[120:123], v[64:79]
    s_waitcnt vmcnt(8) lgkmcnt(4)
    v_cmp_eq_u32 vcc, -1, v126
    ds_read_b64_tr_b16 v[56:57], v180 offset:0
    ds_read_b64_tr_b16 v[58:59], v180 offset:512
    s_add_u32 s56, s55, 16384
    v_mfma_f32_32x32x16_bf16 v[80:95], v[164:167], v[120:123], v[80:95]
    buffer_load_dwordx4 v[96:99], v2, s[36:39], s56 offen offset:0 sc1
    ds_read_b64_tr_b16 v[60:61], v181 offset:0
    ds_read_b64_tr_b16 v[62:63], v181 offset:512
    s_cbranch_vccnz F_gr7
F_gb7:
    v_mfma_f32_32x32x16_bf16 v[64:79], v[168:171], v[124:127], v[64:79]
    s_waitcnt vmcnt(8) lgkmcnt(4)
    v_cmp_eq_u32 vcc, -1, v130
    ds_read_b64_tr_b16 v[160:161], v176 offset:53248
    ds_read_b64_tr_b16 v[162:163], v176 offset:53760
    v_mfma_f32_32x32x16_bf16 v[80:95], v[172:175], v[124:127], v[80:95]
    buffer_load_dwordx4 v[100:103], v2, s[36:39], s56 offen offset:1024 sc1
    ds_read_b64_tr_b16 v[164:165], v177 offset:53248
    ds_read_b64_tr_b16 v[166:167], v177 offset:53760
    s_cbranch_vccnz F_gr8
F_gb8:
    v_mfma_f32_32x32x16_bf16 v[64:79], v[48:51], v[128:131], v[64:79]
    s_waitcnt vmcnt(8) lgkmcnt(4)
    v_cmp_eq_u32 vcc, -1, v134
    ds_read_b64_tr_b16 v[168:169], v176 offset:57344
    ds_read_b64_tr_b16 v[170:171], v176 offset:57856
    v_mfma_f32_32x32x16_bf16 v[80:95], v[52:55], v[128:131], v[80:95]
    buffer_load_dwordx4 v[104:107], v2, s[36:39], s56 offen offset:2048 sc1
    ds_read_b64_tr_b16 v[172:173], v177 offset:57344
    ds_read_b64_tr_b16 v[174:175], v177 offset:57856
    s_cbranch_vccnz F_gr9
F_gb9:
    v_mfma_f32_32x32x16_bf16 v[64:79], v[56:59], v[132:135], v[64:79]
    s_waitcnt vmcnt(8) lgkmcnt(4)
    v_cmp_eq_u32 vcc, -1, v138
    ds_read_b64_tr_b16 v[48:49], v180 offset:4096
    ds_read_b64_tr_b16 v[50:51], v180 offset:4608
    v_mfma_f32_32x32x16_bf16 v[80:95], v[60:63], v[132:135], v[80:95]
    buffer_load_dwordx4 v[108:111], v2, s[36:39], s56 offen offset:3072 sc1
    ds_read_b64_tr_b16 v[52:53], v181 offset:4096
    ds_read_b64_tr_b16 v[54:55], v181 offset:4608
    s_cbranch_vccnz F_gr10
F_gb10:
    v_mfma_f32_32x32x16_bf16 v[64:79], v[160:163], v[136:139], v[64:79]
    s_waitcnt vmcnt(8) lgkmcnt(4)
    v_cmp_eq_u32 vcc, -1, v142
    ds_read_b64_tr_b16 v[56:57], v180 offset:8192
    ds_read_b64_tr_b16 v[58:59], v180 offset:8704
    s_add_u32 s56, s55, 20480
    v_mfma_f32_32x32x16_bf16 v[80:95], v[164:167], v[136:139], v[80:95]
    buffer_load_dwordx4 v[112:115], v2, s[36:39], s56 offen offset:0 sc1
    ds_read_b64_tr_b16 v[60:61], v181 offset:8192
    ds_read_b64_tr_b16 v[62:63], v181 offset:8704
    s_cbranch_vccnz F_gr11
F_gb11:
    v_mfma_f32_32x32x16_bf16 v[64:79], v[168:171], v[140:143], v[64:79]
    s_waitcnt vmcnt(8) lgkmcnt(4)
    v_cmp_eq_u32 vcc, -1, v146
    ds_read_b64_tr_b16 v[160:161], v180 offset:12288
    ds_read_b64_tr_b16 v[162:163], v180 offset:12800
    v_mfma_f32_32x32x16_bf16 v[80:95], v[172:175], v[140:143], v[80:95]
    buffer_load_dwordx4 v[116:119], v2, s[36:39], s56 offen offset:1024 sc1
    ds_read_b64_tr_b16 v[164:165], v181 offset:12288
    ds_read_b64_tr_b16 v[166:167], v181 offset:12800
    s_cbranch_vccnz F_gr12
F_gb12:
    v_mfma_f32_32x32x16_bf16 v[64:79], v[48:51], v[144:147], v[64:79]
    s_waitcnt vmcnt(8) lgkmcnt(4)
    v_cmp_eq_u32 vcc, -1, v150
    ds_read_b64_tr_b16 v[168:169], v178 offset:0
    ds_read_b64_tr_b16 v[170:171], v178 offset:512
    v_mfma_f32_32x32x16_bf16 v[80:95], v[52:55], v[144:147], v[80:95]
    buffer_load_dwordx4 v[120:123], v2, s[36:39], s56 offen offset:2048 sc1
    ds_read_b64_tr_b16 v[172:173], v179 offset:0
    ds_read_b64_tr_b16 v[174:175], v179 offset:512
    s_cbranch_vccnz F_gr13
F_gb13:
    v_mfma_f32_32x32x16_bf16 v[64:79], v[56:59], v[148:151], v[64:79]
    s_waitcnt vmcnt(8) lgkmcnt(4)
    v_cmp_eq_u32 vcc, -1, v154
    ds_read_b64_tr_b16 v[48:49], v178 offset:4096
    ds_read_b64_tr_b16 v[50:51], v178 offset:4608
    v_mfma_f32_32x32x16_bf16 v[80:95], v[60:63], v[148:151], v[80:95]
    buffer_load_dwordx4 v[124:127], v2, s[36:39], s56 offen offset:3072 sc1
    ds_read_b64_tr_b16 v[52:53], v179 offset:4096
    ds_read_b64_tr_b16 v[54:55], v179 offset:4608
    s_cbranch_vccnz F_gr14
F_gb14:
    v_mfma_f32_32x32x16_bf16 v[64:79], v[160:163], v[152:155], v[64:79]
    s_waitcnt vmcnt(8) lgkmcnt(4)
    v_cmp_eq_u32 vcc, -1, v158
    ds_read_b64_tr_b16 v[56:57], v180 offset:16384
    ds_read_b64_tr_b16 v[58:59], v180 offset:16896
    s_add_u32 s56, s55, 24576
    v_mfma_f32_32x32x16_bf16 v[80:95], v[164:167], v[152:155], v[80:95]
    buffer_load_dwordx4 v[128:131], v2, s[36:39], s56 offen offset:0 sc1
    ds_read_b64_tr_b16 v[60:61], v181 offset:16384
    ds_read_b64_tr_b16 v[62:63], v181 offset:16896
    s_cbranch_vccnz F_gr15
F_gb15:
    v_mfma_f32_32x32x16_bf16 v[64:79], v[168:171], v[156:159], v[64:79]
    s_waitcnt vmcnt(8) lgkmcnt(4)
    v_cmp_eq_u32 vcc, -1, v98
    ds_read_b64_tr_b16 v[160:161], v180 offset:20480
    ds_read_b64_tr_b16 v[162:163], v180 offset:20992
    v_mfma_f32_32x32x16_bf16 v[80:95], v[172:175], v[156:159], v[80:95]
    buffer_load_dwordx4 v[132:135], v2, s[36:39], s56 offen offset:1024 sc1
    ds_read_b64_tr_b16 v[164:165], v181 offset:20480
    ds_read_b64_tr_b16 v[166:167], v181 offset:20992
    s_cbranch_vccnz F_gr16
F_gb16:
    v_mfma_f32_32x32x16_bf16 v[64:79], v[48:51], v[96:99], v[64:79]
    s_waitcnt vmcnt(8) lgkmcnt(4)
    v_cmp_eq_u32 vcc, -1, v102
    ds_read_b64_tr_b16 v[168:169], v180 offset:24576
    ds_read_b64_tr_b16 v[170:171], v180 offset:25088
    v_mfma_f32_32x32x16_bf16 v[80:95], v[52:55], v[96:99], v[80:95]
    buffer_load_dwordx4 v[136:139], v2, s[36:39], s56 offen offset:2048 sc1
    ds_read_b64_tr_b16 v[172:173], v181 offset:24576
    ds_read_b64_tr_b16 v[174:175], v181 offset:25088
    s_cbranch_vccnz F_gr17
F_gb17:
    v_mfma_f32_32x32x16_bf16 v[64:79], v[56:59], v[100:103], v[64:79]
    s_waitcnt vmcnt(8) lgkmcnt(4)
    v_cmp_eq_u32 vcc, -1, v106
    ds_read_b64_tr_b16 v[48:49], v178 offset:8192
    ds_read_b64_tr_b16 v[50:51], v178 offset:8704
    v_mfma_f32_32x32x16_bf16 v[80:95], v[60:63], v[100:103], v[80:95]
    buffer_load_dwordx4 v[140:143], v2, s[36:39], s56 offen offset:3072 sc1
    ds_read_b64_tr_b16 v[52:53], v179 offset:8192
    ds_read_b64_tr_b16 v[54:55], v179 offset:8704
    s_cbranch_vccnz F_gr18
F_gb18:
    v_mfma_f32_32x32x16_bf16 v[64:79], v[160:163], v[104:107], v[64:79]
    s_waitcnt vmcnt(8) lgkmcnt(4)
    v_cmp_eq_u32 vcc, -1, v110
    ds_read_b64_tr_b16 v[56:57], v178 offset:12288
    ds_read_b64_tr_b16 v[58:59], v178 offset:12800
    s_add_u32 s56, s55, 28672
    v_mfma_f32_32x32x16_bf16 v[80:95], v[164:167], v[104:107], v[80:95]
    buffer_load_dwordx4 v[144:147], v2, s[36:39], s56 offen offset:0 sc1
    ds_read_b64_tr_b16 v[60:61], v179 offset:12288
    ds_read_b64_tr_b16 v[62:63], v179 offset:12800
    s_cbranch_vccnz F_gr19
F_gb19:
    v_mfma_f32_32x32x16_bf16 v[64:79], v[168:171], v[108:111], v[64:79]
    s_waitcnt vmcnt(8) lgkmcnt(4)
    v_cmp_eq_u32 vcc, -1, v114
    ds_read_b64_tr_b16 v[160:161], v180 offset:28672
    ds_read_b64_tr_b16 v[162:163], v180 offset:29184
    v_mfma_f32_32x32x16_bf16 v[80:95], v[172:175], v[108:111], v[80:95]
    buffer_load_dwordx4 v[148:151], v2, s[36:39], s56 offen offset:1024 sc1
    ds_read_b64_tr_b16 v[164:165], v181 offset:28672
    ds_read_b64_tr_b16 v[166:167], v181 offset:29184
    s_cbranch_vccnz F_gr20
F_gb20:
    v_mfma_f32_32x32x16_bf16 v[64:79], v[48:51], v[112:115], v[64:79]
    s_waitcnt vmcnt(8) lgkmcnt(4)
    v_cmp_eq_u32 vcc, -1, v118
    ds_read_b64_tr_b16 v[168:169], v180 offset:32768
    ds_read_b64_tr_b16 v[170:171], v180 offset:33280
    v_mfma_f32_32x32x16_bf16 v[80:95], v[52:55], v[112:115], v[80:95]
    buffer_load_dwordx4 v[152:155], v2, s[36:39], s56 offen offset:2048 sc1
    ds_read_b64_tr_b16 v[172:173], v181 offset:32768
    ds_read_b64_tr_b16 v[174:175], v181 offset:33280
    s_cbranch_vccnz F_gr21
F_gb21:
    v_mfma_f32_32x32x16_bf16 v[64:79], v[56:59], v[116:119], v[64:79]
    s_waitcnt vmcnt(8) lgkmcnt(4)
    v_cmp_eq_u32 vcc, -1, v122
    ds_read_b64_tr_b16 v[48:49], v180 offset:36864
    ds_read_b64_tr_b16 v[50:51], v180 offset:37376
    v_mfma_f32_32x32x16_bf16 v[80:95], v[60:63], v[116:119], v[80:95]
    buffer_load_dwordx4 v[156:159], v2, s[36:39], s56 offen offset:3072 sc1
    ds_read_b64_tr_b16 v[52:53], v181 offset:36864
    ds_read_b64_tr_b16 v[54:55], v181 offset:37376
    s_cbranch_vccnz F_gr22
F_gb22:
    v_mfma_f32_32x32x16_bf16 v[64:79], v[160:163], v[120:123], v[64:79]
    s_waitcnt vmcnt(8) lgkmcnt(4)
    v_cmp_eq_u32 vcc, -1, v126
    ds_read_b64_tr_b16 v[56:57], v178 offset:40960
    ds_read_b64_tr_b16 v[58:59], v178 offset:41472
    s_add_u32 s56, s55, 32768
    v_mfma_f32_32x32x16_bf16 v[80:95], v[164:167], v[120:123], v[80:95]
    buffer_load_dwordx4 v[96:99], v2, s[36:39], s56 offen offset:0 sc1
    ds_read_b64_tr_b16 v[60:61], v179 offset:40960
    ds_read_b64_tr_b16 v[62:63], v179 offset:41472
    s_cbranch_vccnz F_gr23
F_gb23:
    v_mfma_f32_32x32x16_bf16 v[64:79], v[168:171], v[124:127], v[64:79]
    s_waitcnt vmcnt(8) lgkmcnt(4)
    v_cmp_eq_u32 vcc, -1, v130
    ds_read_b64_tr_b16 v[160:161], v178 offset:45056
    ds_read_b64_tr_b16 v[162:163], v178 offset:45568
    v_mfma_f32_32x32x16_bf16 v[80:95], v[172:175], v[124:127], v[80:95]
    buffer_load_dwordx4 v[100:103], v2, s[36:39], s56 offen offset:1024 sc1
    ds_read_b64_tr_b16 v[164:165], v179 offset:45056
    ds_read_b64_tr_b16 v[166:167], v179 offset:45568
    s_cbranch_vccnz F_gr24
F_gb24:
    s_barrier
    v_mfma_f32_32x32x16_bf16 v[64:79], v[48:51], v[128:131], v[64:79]
    s_waitcnt vmcnt(8) lgkmcnt(4)
    v_cmp_eq_u32 vcc, -1, v134
    ds_read_b64_tr_b16 v[168:169], v178 offset:49152
    ds_read_b64_tr_b16 v[170:171], v178 offset:49664
    v_mfma_f32_32x32x16_bf16 v[80:95], v[52:55], v[128:131], v[80:95]
    buffer_load_dwordx4 v[104:107], v2, s[36:39], s56 offen offset:2048 sc1
    ds_read_b64_tr_b16 v[172:173], v179 offset:49152
    ds_read_b64_tr_b16 v[174:175], v179 offset:49664
    s_cbranch_vccnz F_gr25
F_gb25:
    v_mfma_f32_32x32x16_bf16 v[64:79], v[56:59], v[132:135], v[64:79]
    s_waitcnt vmcnt(8) lgkmcnt(4)
    v_cmp_eq_u32 vcc, -1, v138
    ds_read_b64_tr_b16 v[48:49], v178 offset:16384
    ds_read_b64_tr_b16 v[50:51], v178 offset:16896
    v_mfma_f32_32x32x16_bf16 v[80:95], v[60:63], v[132:135], v[80:95]
    buffer_load_dwordx4 v[108:111], v2, s[36:39], s56 offen offset:3072 sc1
    ds_read_b64_tr_b16 v[52:53], v179 offset:16384
    ds_read_b64_tr_b16 v[54:55], v179 offset:16896
    s_cbranch_vccnz F_gr26
F_gb26:
    v_mfma_f32_32x32x16_bf16 v[64:79], v[160:163], v[136:139], v[64:79]
    s_waitcnt vmcnt(8) lgkmcnt(4)
    v_cmp_eq_u32 vcc, -1, v142
    ds_read_b64_tr_b16 v[56:57], v178 offset:20480
    ds_read_b64_tr_b16 v[58:59], v178 offset:20992
    s_add_u32 s56, s55, 36864
    v_mfma_f32_32x32x16_bf16 v[80:95], v[164:167], v[136:139], v[80:95]
    buffer_load_dwordx4 v[112:115], v2, s[36:39], s56 offen offset:0 sc1
    ds_read_b64_tr_b16 v[60:61], v179 offset:20480
    ds_read_b64_tr_b16 v[62:63], v179 offset:20992
    s_cbranch_vccnz F_gr27
F_gb27:
    v_mfma_f32_32x32x16_bf16 v[64:79], v[168:171], v[140:143], v[64:79]
    s_waitcnt vmcnt(8) lgkmcnt(4)
    v_cmp_eq_u32 vcc, -1, v146
    ds_read_b64_tr_b16 v[160:161], v176 offset:0
    ds_read_b64_tr_b16 v[162:163], v176 offset:512
    v_mfma_f32_32x32x16_bf16 v[80:95], v[172:175], v[140:143], v[80:95]
    buffer_load_dwordx4 v[116:119], v2, s[36:39], s56 offen offset:1024 sc1
    ds_read_b64_tr_b16 v[164:165], v177 offset:0
    ds_read_b64_tr_b16 v[166:167], v177 offset:512
    s_cbranch_vccnz F_gr28
F_gb28:
    v_mfma_f32_32x32x16_bf16 v[64:79], v[48:51], v[144:147], v[64:79]
    s_waitcnt vmcnt(8) lgkmcnt(4)
    v_cmp_eq_u32 vcc, -1, v150
    ds_read_b64_tr_b16 v[168:169], v176 offset:4096
    ds_read_b64_tr_b16 v[170:171], v176 offset:4608
    v_mfma_f32_32x32x16_bf16 v[80:95], v[52:55], v[144:147], v[80:95]
    buffer_load_dwordx4 v[120:123], v2, s[36:39], s56 offen offset:2048 sc1
    ds_read_b64_tr_b16 v[172:173], v177 offset:4096
    ds_read_b64_tr_b16 v[174:175], v177 offset:4608
    s_cbranch_vccnz F_gr29
F_gb29:
    v_mfma_f32_32x32x16_bf16 v[64:79], v[56:59], v[148:151], v[64:79]
    s_waitcnt vmcnt(8) lgkmcnt(4)
    v_cmp_eq_u32 vcc, -1, v154
    ds_read_b64_tr_b16 v[48:49], v176 offset:8192
    ds_read_b64_tr_b16 v[50:51], v176 offset:8704
    v_mfma_f32_32x32x16_bf16 v[80:95], v[60:63], v[148:151], v[80:95]
    buffer_load_dwordx4 v[124:127], v2, s[36:39], s56 offen offset:3072 sc1
    ds_read_b64_tr_b16 v[52:53], v177 offset:8192
    ds_read_b64_tr_b16 v[54:55], v177 offset:8704
    s_cbranch_vccnz F_gr30
F_gb30:
    v_mfma_f32_32x32x16_bf16 v[64:79], v[160:163], v[152:155], v[64:79]
    s_waitcnt vmcnt(8) lgkmcnt(4)
    v_cmp_eq_u32 vcc, -1, v158
    ds_read_b64_tr_b16 v[56:57], v178 offset:24576
    ds_read_b64_tr_b16 v[58:59], v178 offset:25088
    s_add_u32 s56, s55, 40960
    v_mfma_f32_32x32x16_bf16 v[80:95], v[164:167], v[152:155], v[80:95]
    buffer_load_dwordx4 v[128:131], v2, s[36:39], s56 offen offset:0 sc1
    ds_read_b64_tr_b16 v[60:61], v179 offset:24576
    ds_read_b64_tr_b16 v[62:63], v179 offset:25088
    s_cbranch_vccnz F_gr31
F_gb31:
    v_mfma_f32_32x32x16_bf16 v[64:79], v[168:171], v[156:159], v[64:79]
    s_waitcnt vmcnt(8) lgkmcnt(4)
    v_cmp_eq_u32 vcc, -1, v98
    ds_read_b64_tr_b16 v[160:161], v178 offset:28672
    ds_read_b64_tr_b16 v[162:163], v178 offset:29184
    v_mfma_f32_32x32x16_bf16 v[80:95], v[172:175], v[156:159], v[80:95]
    buffer_load_dwordx4 v[132:135], v2, s[36:39], s56 offen offset:1024 sc1
    ds_read_b64_tr_b16 v[164:165], v179 offset:28672
    ds_read_b64_tr_b16 v[166:167], v179 offset:29184
    s_cbranch_vccnz F_gr32
F_gb32:
    v_mfma_f32_32x32x16_bf16 v[64:79], v[48:51], v[96:99], v[64:79]
    s_waitcnt vmcnt(8) lgkmcnt(4)
    v_cmp_eq_u32 vcc, -1, v102
    ds_read_b64_tr_b16 v[168:169], v176 offset:12288
    ds_read_b64_tr_b16 v[170:171], v176 offset:12800
    v_mfma_f32_32x32x16_bf16 v[80:95], v[52:55], v[96:99], v[80:95]
    buffer_load_dwordx4 v[136:139], v2, s[36:39], s56 offen offset:2048 sc1
    ds_read_b64_tr_b16 v[172:173], v177 offset:12288
    ds_read_b64_tr_b16 v[174:175], v177 offset:12800
    s_cbranch_vccnz F_gr33
F_gb33:
    v_mfma_f32_32x32x16_bf16 v[64:79], v[56:59], v[100:103], v[64:79]
    s_waitcnt vmcnt(8) lgkmcnt(4)
    v_cmp_eq_u32 vcc, -1, v106
    ds_read_b64_tr_b16 v[48:49], v176 offset:16384
    ds_read_b64_tr_b16 v[50:51], v176 offset:16896
    v_mfma_f32_32x32x16_bf16 v[80:95], v[60:63], v[100:103], v[80:95]
    ds_read_b64_tr_b16 v[52:53], v177 offset:16384
    ds_read_b64_tr_b16 v[54:55], v177 offset:16896
    s_cbranch_vccnz F_gr34
F_gb34:
    v_mfma_f32_32x32x16_bf16 v[64:79], v[160:163], v[104:107], v[64:79]
    s_waitcnt vmcnt(7) lgkmcnt(4)
    v_cmp_eq_u32 vcc, -1, v110
    ds_read_b64_tr_b16 v[56:57], v176 offset:20480
    ds_read_b64_tr_b16 v[58:59], v176 offset:20992
    v_mfma_f32_32x32x16_bf16 v[80:95], v[164:167], v[104:107], v[80:95]
    ds_read_b64_tr_b16 v[60:61], v177 offset:20480
    ds_read_b64_tr_b16 v[62:63], v177 offset:20992
    s_cbranch_vccnz F_gr35
F_gb35:
    v_mfma_f32_32x32x16_bf16 v[64:79], v[168:171], v[108:111], v[64:79]
    s_waitcnt vmcnt(6) lgkmcnt(4)
    v_cmp_eq_u32 vcc, -1, v114
    ds_read_b64_tr_b16 v[160:161], v178 offset:32768
    ds_read_b64_tr_b16 v[162:163], v178 offset:33280
    v_mfma_f32_32x32x16_bf16 v[80:95], v[172:175], v[108:111], v[80:95]
    ds_read_b64_tr_b16 v[164:165], v179 offset:32768
    ds_read_b64_tr_b16 v[166:167], v179 offset:33280
    s_cbranch_vccnz F_gr36
F_gb36:
    v_mfma_f32_32x32x16_bf16 v[64:79], v[48:51], v[112:115], v[64:79]
    s_waitcnt vmcnt(5) lgkmcnt(4)
    v_cmp_eq_u32 vcc, -1, v118
    ds_read_b64_tr_b16 v[168:169], v178 offset:36864
    ds_read_b64_tr_b16 v[170:171], v178 offset:37376
    v_mfma_f32_32x32x16_bf16 v[80:95], v[52:55], v[112:115], v[80:95]
    ds_read_b64_tr_b16 v[172:173], v179 offset:36864
    ds_read_b64_tr_b16 v[174:175], v179 offset:37376
    s_cbranch_vccnz F_gr37
F_gb37:
    v_mfma_f32_32x32x16_bf16 v[64:79], v[56:59], v[116:119], v[64:79]
    s_waitcnt vmcnt(4) lgkmcnt(4)
    v_cmp_eq_u32 vcc, -1, v122
    ds_read_b64_tr_b16 v[48:49], v176 offset:24576
    ds_read_b64_tr_b16 v[50:51], v176 offset:25088
    v_mfma_f32_32x32x16_bf16 v[80:95], v[60:63], v[116:119], v[80:95]
    ds_read_b64_tr_b16 v[52:53], v177 offset:24576
    ds_read_b64_tr_b16 v[54:55], v177 offset:25088
    s_cbranch_vccnz F_gr38
F_gb38:
    v_mfma_f32_32x32x16_bf16 v[64:79], v[160:163], v[120:123], v[64:79]
    s_waitcnt vmcnt(3) lgkmcnt(4)
    v_cmp_eq_u32 vcc, -1, v126
    ds_read_b64_tr_b16 v[56:57], v176 offset:28672
    ds_read_b64_tr_b16 v[58:59], v176 offset:29184
    v_mfma_f32_32x32x16_bf16 v[80:95], v[164:167], v[120:123], v[80:95]
    ds_read_b64_tr_b16 v[60:61], v177 offset:28672
    ds_read_b64_tr_b16 v[62:63], v177 offset:29184
    s_cbranch_vccnz F_gr39
F_gb39:
    v_mfma_f32_32x32x16_bf16 v[64:79], v[168:171], v[124:127], v[64:79]
    s_waitcnt vmcnt(2) lgkmcnt(4)
    v_cmp_eq_u32 vcc, -1, v130
    ds_read_b64_tr_b16 v[160:161], v176 offset:32768
    ds_read_b64_tr_b16 v[162:163], v176 offset:33280
    v_mfma_f32_32x32x16_bf16 v[80:95], v[172:175], v[124:127], v[80:95]
    ds_read_b64_tr_b16 v[164:165], v177 offset:32768
    ds_read_b64_tr_b16 v[166:167], v177 offset:33280
    s_cbranch_vccnz F_gr40
F_gb40:
    s_waitcnt vmcnt(1) lgkmcnt(4)
    v_cmp_eq_u32 vcc, -1, v134
    v_mfma_f32_32x32x16_bf16 v[80:95], v[52:55], v[128:131], v[80:95]
    s_cbranch_vccnz F_gr41
F_gb41:
    s_waitcnt vmcnt(0) lgkmcnt(0)
    v_cmp_eq_u32 vcc, -1, v138
    v_mfma_f32_32x32x16_bf16 v[80:95], v[60:63], v[132:135], v[80:95]
    s_cbranch_vccnz F_gr42
F_gb42:
    v_mfma_f32_32x32x16_bf16 v[80:95], v[164:167], v[136:139], v[80:95]
    v_mfma_f32_32x32x16_bf16 v[64:79], v[48:51], v[128:131], v[64:79]
    s_nop 4
    v_mfma_f32_32x32x16_bf16 v[64:79], v[56:59], v[132:135], v[64:79]
    s_nop 4
    ds_write_b128 v14, v[80:83] offset:0
    ds_write_b128 v14, v[84:87] offset:1024
    v_mfma_f32_32x32x16_bf16 v[64:79], v[160:163], v[136:139], v[64:79]
    ds_write_b128 v14, v[88:91] offset:2048
    ds_write_b128 v14, v[92:95] offset:3072
    s_waitcnt lgkmcnt(0)
    s_barrier
    ds_read_b128 v[48:51], v15 offset:0
    ds_read_b128 v[52:55], v15 offset:1024
    ds_read_b128 v[56:59], v15 offset:2048
    ds_read_b128 v[60:63], v15 offset:3072
    s_waitcnt lgkmcnt(3)
    s_nop 2
    v_pk_add_f32 v[64:65], v[64:65], v[48:49]
    v_pk_add_f32 v[66:67], v[66:67], v[50:51]
    v_cvt_pk_bf16_f32 v40, v64, v65
    v_cvt_pk_bf16_f32 v41, v66, v67
    s_waitcnt lgkmcnt(2)
    v_pk_add_f32 v[68:69], v[68:69], v[52:53]
    v_pk_add_f32 v[70:71], v[70:71], v[54:55]
    v_cvt_pk_bf16_f32 v42, v68, v69
    v_cvt_pk_bf16_f32 v43, v70, v71
    ds_write_b128 v200, v[40:43] offset:16384
    s_waitcnt lgkmcnt(2)
    v_pk_add_f32 v[72:73], v[72:73], v[56:57]
    v_pk_add_f32 v[74:75], v[74:75], v[58:59]
    v_cvt_pk_bf16_f32 v44, v72, v73
    v_cvt_pk_bf16_f32 v45, v74, v75
    s_waitcnt lgkmcnt(1)
    v_pk_add_f32 v[76:77], v[76:77], v[60:61]
    v_pk_add_f32 v[78:79], v[78:79], v[62:63]
    v_cvt_pk_bf16_f32 v46, v76, v77
    v_cvt_pk_bf16_f32 v47, v78, v79
    ds_write_b128 v201, v[44:47] offset:16384
    ds_read_b128 v[96:99], v202 offset:16384
    ds_read_b128 v[100:103], v202 offset:17408
    s_add_u32 s63, s58, 16384
    s_waitcnt lgkmcnt(1)
    buffer_store_dwordx4 v[96:99], v203, s[32:35], s58 offen nt
    s_waitcnt lgkmcnt(0)
    buffer_store_dwordx4 v[100:103], v203, s[32:35], s63 offen nt
    s_branch B_end
F_rra0:
    ds_read_b64_tr_b16 v[40:41], v9 offset:0
    ds_read_b64_tr_b16 v[42:43], v9 offset:256
    ds_read_b64_tr_b16 v[44:45], v9 offset:512
    ds_read_b64_tr_b16 v[46:47], v9 offset:768
    s_branch F_nra0
F_rra1:
    ds_read_b64_tr_b16 v[40:41], v9 offset:8192
    ds_read_b64_tr_b16 v[42:43], v9 offset:8448
    ds_read_b64_tr_b16 v[44:45], v9 offset:8704
    ds_read_b64_tr_b16 v[46:47], v9 offset:8960
    s_branch F_nra1
F_rra2:
    ds_read_b64_tr_b16 v[40:41], v9 offset:16384
    ds_read_b64_tr_b16 v[42:43], v9 offset:16640
    ds_read_b64_tr_b16 v[44:45], v9 offset:16896
    ds_read_b64_tr_b16 v[46:47], v9 offset:17152
    s_branch F_nra2
F_rra3:
    ds_read_b64_tr_b16 v[40:41], v9 offset:24576
    ds_read_b64_tr_b16 v[42:43], v9 offset:24832
    ds_read_b64_tr_b16 v[44:45], v9 offset:25088
    ds_read_b64_tr_b16 v[46:47], v9 offset:25344
    s_branch F_nra3
F_rra4:
    ds_read_b64_tr_b16 v[40:41], v9 offset:32768
    ds_read_b64_tr_b16 v[42:43], v9 offset:33024
    ds_read_b64_tr_b16 v[44:45], v9 offset:33280
    ds_read_b64_tr_b16 v[46:47], v9 offset:33536
    s_branch F_nra4
F_rra5:
    ds_read_b64_tr_b16 v[40:41], v9 offset:40960
    ds_read_b64_tr_b16 v[42:43], v9 offset:41216
    ds_read_b64_tr_b16 v[44:45], v9 offset:41472
    ds_read_b64_tr_b16 v[46:47], v9 offset:41728
    s_branch F_nra5
F_rra6:
    ds_read_b64_tr_b16 v[40:41], v9 offset:49152
    ds_read_b64_tr_b16 v[42:43], v9 offset:49408
    ds_read_b64_tr_b16 v[44:45], v9 offset:49664
    ds_read_b64_tr_b16 v[46:47], v9 offset:49920
    s_branch F_nra6
F_rra7:
    ds_read_b64_tr_b16 v[40:41], v9 offset:57344
    ds_read_b64_tr_b16 v[42:43], v9 offset:57600
    ds_read_b64_tr_b16 v[44:45], v9 offset:57856
    ds_read_b64_tr_b16 v[46:47], v9 offset:58112
    s_branch F_nra7
F_rra8:
    ds_read_b64_tr_b16 v[40:41], v9 offset:0
    ds_read_b64_tr_b16 v[42:43], v9 offset:256
    ds_read_b64_tr_b16 v[44:45], v9 offset:512
    ds_read_b64_tr_b16 v[46:47], v9 offset:768
    s_branch F_nra8
F_rra9:
    ds_read_b64_tr_b16 v[40:41], v9 offset:8192
    ds_read_b64_tr_b16 v[42:43], v9 offset:8448
    ds_read_b64_tr_b16 v[44:45], v9 offset:8704
    ds_read_b64_tr_b16 v[46:47], v9 offset:8960
    s_branch F_nra9
F_rra10:
    ds_read_b64_tr_b16 v[40:41], v9 offset:16384
    ds_read_b64_tr_b16 v[42:43], v9 offset:16640
    ds_read_b64_tr_b16 v[44:45], v9 offset:16896
    ds_read_b64_tr_b16 v[46:47], v9 offset:17152
    s_branch F_nra10
F_rra11:
    ds_read_b64_tr_b16 v[40:41], v9 offset:24576
    ds_read_b64_tr_b16 v[42:43], v9 offset:24832
    ds_read_b64_tr_b16 v[44:45], v9 offset:25088
    ds_read_b64_tr_b16 v[46:47], v9 offset:25344
    s_branch F_nra11
F_rra12:
    ds_read_b64_tr_b16 v[40:41], v9 offset:32768
    ds_read_b64_tr_b16 v[42:43], v9 offset:33024
    ds_read_b64_tr_b16 v[44:45], v9 offset:33280
    ds_read_b64_tr_b16 v[46:47], v9 offset:33536
    s_branch F_nra12
F_rra13:
    ds_read_b64_tr_b16 v[40:41], v9 offset:40960
    ds_read_b64_tr_b16 v[42:43], v9 offset:41216
    ds_read_b64_tr_b16 v[44:45], v9 offset:41472
    ds_read_b64_tr_b16 v[46:47], v9 offset:41728
    s_branch F_nra13
F_rra14:
    ds_read_b64_tr_b16 v[40:41], v9 offset:49152
    ds_read_b64_tr_b16 v[42:43], v9 offset:49408
    ds_read_b64_tr_b16 v[44:45], v9 offset:49664
    ds_read_b64_tr_b16 v[46:47], v9 offset:49920
    s_branch F_nra14
F_rra15:
    ds_read_b64_tr_b16 v[40:41], v9 offset:57344
    ds_read_b64_tr_b16 v[42:43], v9 offset:57600
    ds_read_b64_tr_b16 v[44:45], v9 offset:57856
    ds_read_b64_tr_b16 v[46:47], v9 offset:58112
    s_branch F_nra15
F_lstat:
    s_mov_b32 s3, s17
    v_and_b32 v1, 63, v0
    v_lshlrev_b32 v2, 4, v1
    s_add_u32 s36, s30, 0x510000
    s_addc_u32 s37, s31, 0
    s_mov_b32 s38, 0x560000
    s_mov_b32 s39, 0x20000
    s_mov_b32 s20, s28
    s_mov_b32 s21, s29
    s_mov_b32 s22, 0x158000
    s_mov_b32 s23, 0x20000
    s_waitcnt lgkmcnt(0)
    s_mov_b32 s32, s10
    s_mov_b32 s33, s11
    s_mov_b32 s34, 0x200000
    s_mov_b32 s35, 0x20000
    s_lshl_b32 s24, s3, 2
    s_add_u32 s24, s24, s19
    s_lshl_b32 s25, s19, 11
    v_add_u32 v3, s25, v2
    v_add_u32 v3, 36864, v3
    v_add_u32 v4, 8, v3
    s_lshl_b32 s26, s19, 10
    s_lshr_b32 s8, s2, 6
    s_bfe_u32 s9, s2, 0x10001
    s_lshl_b32 s9, s9, 2
    s_add_u32 s8, s8, s9
    s_and_b32 s9, s2, 1
    s_xor_b32 s8, s8, 0
    s_lshl_b32 s9, s9, 1
    s_add_u32 s9, s9, s62
    s_lshl_b32 s12, s3, 2
    s_add_u32 s12, s12, s9
    s_lshl_b32 s13, s8, 7
    s_lshl_b32 s14, s62, 13
    s_add_u32 s14, s14, s13
    s_mul_i32 s15, s12, 88064
    s_mul_i32 s55, s61, 44032
    s_add_u32 s55, s55, s15
    s_mul_i32 s63, s61, 737280
    s_add_u32 s52, s63, s14
    s_mul_i32 s63, s61, 16384
    s_add_u32 s53, s63, s14
    s_mul_i32 s63, s61, 688128
    s_add_u32 s54, s63, s14
    s_lshl_b32 s58, s12, 15
    s_add_u32 s58, s58, s13
    s_lshl_b32 s63, s61, 6
    s_add_u32 s58, s58, s63
    s_lshl_b32 s27, s8, 1
    s_add_u32 s27, s27, s61
    s_sub_u32 s27, s27, s5
    s_and_b32 s27, s27, 15
    v_lshrrev_b32 v6, 3, v1
    v_and_b32 v7, 7, v1
    v_bfe_u32 v8, v1, 4, 1
    v_lshlrev_b32 v9, 2, v8
    v_xor_b32 v7, v7, v9
    v_lshlrev_b32 v6, 10, v6
    v_lshl_add_u32 v6, v7, 4, v6
    v_lshrrev_b32 v12, 5, v1
    v_bfe_u32 v13, v1, 2, 2
    v_lshl_add_u32 v9, v12, 3, v13
    v_lshlrev_b32 v10, 7, v9
    v_lshrrev_b32 v9, 1, v13
    v_xor_b32 v9, s61, v9
    v_lshl_add_u32 v10, v9, 6, v10
    v_and_b32 v9, 1, v1
    v_bfe_u32 v11, v1, 1, 1
    v_lshl_add_u32 v11, v8, 1, v11
    v_lshl_add_u32 v9, v9, 2, v11
    v_lshl_add_u32 v10, v9, 3, v10
    v_lshl_add_u32 v176, s61, 11, v10
    v_xor_b32 v177, 64, v176
    v_add_u32 v178, 61440, v176
    v_add_u32 v179, 61440, v177
    v_add_u32 v180, 122880, v176
    v_add_u32 v181, 122880, v177
    v_lshl_add_u32 v9, v12, 4, v13
    v_lshlrev_b32 v9, 6, v9
    v_lshl_add_u32 v9, v8, 5, v9
    v_and_b32 v13, 3, v1
    v_lshl_add_u32 v9, v13, 3, v9
    v_lshl_add_u32 v9, s9, 11, v9
    v_add_u32 v9, 36864, v9
    v_and_b32 v13, 31, v1
    v_lshlrev_b32 v13, 10, v13
    v_lshl_add_u32 v12, v12, 5, v13
    s_mov_b32 s18, 262144
    s_mov_b32 s7, 262144
    v_and_b32 v14, 3, v1
    v_lshlrev_b32 v14, 4, v14
    v_bfe_u32 v15, v1, 2, 1
    v_mul_u32_u24 v15, 16640, v15
    v_add_u32 v14, v15, v14
    v_bfe_u32 v15, v1, 3, 1
    v_lshl_add_u32 v14, v15, 10, v14
    v_lshrrev_b32 v15, 4, v1
    v_lshl_add_u32 v14, v15, 6, v14
    s_and_b32 s28, s24, 7
    s_lshl_b32 s28, s28, 11
    s_mul_i32 s24, s24, 33280
    v_add_u32 v14, s24, v14
    v_add_u32 v15, 256, v14
    v_add_u32 v14, 1024, v14
    s_waitcnt vmcnt(0)
F_tks:
    v_cmp_ne_u64 vcc, v[42:43], v[220:221]
    s_cbranch_vccz F_tkos
    s_mov_b64 exec, vcc
    buffer_load_dwordx2 v[42:43], v44, s[40:43], 0 offen sc1
    s_waitcnt vmcnt(0)
    s_sub_u32 s7, s7, 1
    s_cbranch_scc0 F_tks
    s_mov_b32 s7, 0
F_tkos:
    s_mov_b64 exec, -1
    s_barrier
    s_mul_i32 s63, s9, 30720
    s_lshl_b32 s64, s27, 11
    s_add_u32 s63, s63, s64
    s_sub_u32 s63, s63, 35840
    v_add_u32 v9, s63, v9
    s_barrier
    ds_read_b64_tr_b16 v[40:41], v9 offset:0
    ds_read_b64_tr_b16 v[42:43], v9 offset:256
    ds_read_b64_tr_b16 v[44:45], v9 offset:512
    ds_read_b64_tr_b16 v[46:47], v9 offset:768
    s_waitcnt lgkmcnt(0)
    s_barrier
    s_add_u32 m0, s26, 102400
    s_add_u32 s63, s52, 0
    buffer_load_dwordx4 v6, s[20:23], s63 offen lds
    s_add_u32 m0, s26, 106496
    s_add_u32 s63, s52, 49152
    buffer_load_dwordx4 v6, s[20:23], s63 offen lds
    s_add_u32 m0, s26, 110592
    s_add_u32 s63, s52, 98304
    buffer_load_dwordx4 v6, s[20:23], s63 offen lds
    s_add_u32 m0, s26, 36864
    s_add_u32 s63, s52, 147456
    buffer_load_dwordx4 v6, s[20:23], s63 offen lds
    s_add_u32 m0, s26, 40960
    s_add_u32 s63, s52, 196608
    buffer_load_dwordx4 v6, s[20:23], s63 offen lds
    s_add_u32 m0, s26, 45056
    s_add_u32 s63, s52, 245760
    buffer_load_dwordx4 v6, s[20:23], s63 offen lds
    s_add_u32 m0, s26, 49152
    s_add_u32 s63, s52, 294912
    buffer_load_dwordx4 v6, s[20:23], s63 offen lds
    s_add_u32 m0, s26, 114688
    s_add_u32 s63, s52, 344064
    buffer_load_dwordx4 v6, s[20:23], s63 offen lds
    s_add_u32 m0, s26, 118784
    s_add_u32 s63, s52, 393216
    buffer_load_dwordx4 v6, s[20:23], s63 offen lds
    s_add_u32 m0, s26, 122880
    s_add_u32 s63, s52, 442368
    buffer_load_dwordx4 v6, s[20:23], s63 offen lds
    s_add_u32 m0, s26, 53248
    s_add_u32 s63, s52, 491520
    buffer_load_dwordx4 v6, s[20:23], s63 offen lds
    s_add_u32 m0, s26, 57344
    s_add_u32 s63, s52, 540672
    buffer_load_dwordx4 v6, s[20:23], s63 offen lds
    s_add_u32 m0, s26, 126976
    s_add_u32 s63, s52, 589824
    buffer_load_dwordx4 v6, s[20:23], s63 offen lds
    s_add_u32 m0, s26, 131072
    s_add_u32 s63, s52, 638976
    buffer_load_dwordx4 v6, s[20:23], s63 offen lds
    s_add_u32 m0, s26, 135168
    s_add_u32 s63, s53, 688128
    buffer_load_dwordx4 v6, s[20:23], s63 offen lds
    s_add_u32 m0, s26, 61440
    s_add_u32 s63, s52, 16384
    buffer_load_dwordx4 v6, s[20:23], s63 offen lds
    s_add_u32 m0, s26, 65536
    s_add_u32 s63, s52, 65536
    buffer_load_dwordx4 v6, s[20:23], s63 offen lds
    s_add_u32 m0, s26, 139264
    s_add_u32 s63, s52, 114688
    buffer_load_dwordx4 v6, s[20:23], s63 offen lds
    s_add_u32 m0, s26, 143360
    s_add_u32 s63, s52, 163840
    buffer_load_dwordx4 v6, s[20:23], s63 offen lds
    s_add_u32 m0, s26, 147456
    s_add_u32 s63, s52, 212992
    buffer_load_dwordx4 v6, s[20:23], s63 offen lds
    s_add_u32 m0, s26, 69632
    s_add_u32 s63, s52, 262144
    buffer_load_dwordx4 v6, s[20:23], s63 offen lds
    s_add_u32 m0, s26, 73728
    s_add_u32 s63, s52, 311296
    buffer_load_dwordx4 v6, s[20:23], s63 offen lds
    s_add_u32 m0, s26, 151552
    s_add_u32 s63, s52, 360448
    buffer_load_dwordx4 v6, s[20:23], s63 offen lds
    s_add_u32 m0, s26, 155648
    s_add_u32 s63, s52, 409600
    buffer_load_dwordx4 v6, s[20:23], s63 offen lds
    s_add_u32 m0, s26, 159744
    s_add_u32 s63, s52, 458752
    buffer_load_dwordx4 v6, s[20:23], s63 offen lds
    s_add_u32 m0, s26, 77824
    s_add_u32 s63, s52, 655360
    buffer_load_dwordx4 v6, s[20:23], s63 offen lds
    s_add_u32 m0, s26, 81920
    s_add_u32 s63, s54, 32768
    buffer_load_dwordx4 v6, s[20:23], s63 offen lds
    s_add_u32 m0, s26, 0
    s_add_u32 s63, s54, 81920
    buffer_load_dwordx4 v6, s[20:23], s63 offen lds
    s_add_u32 m0, s26, 4096
    s_add_u32 s63, s54, 131072
    buffer_load_dwordx4 v6, s[20:23], s63 offen lds
    s_add_u32 m0, s26, 8192
    s_add_u32 s63, s54, 180224
    buffer_load_dwordx4 v6, s[20:23], s63 offen lds
    s_add_u32 m0, s26, 86016
    s_add_u32 s63, s54, 229376
    buffer_load_dwordx4 v6, s[20:23], s63 offen lds
    s_add_u32 m0, s26, 90112
    s_add_u32 s63, s54, 278528
    buffer_load_dwordx4 v6, s[20:23], s63 offen lds
    s_add_u32 m0, s26, 12288
    s_add_u32 s63, s54, 327680
    buffer_load_dwordx4 v6, s[20:23], s63 offen lds
    s_add_u32 m0, s26, 16384
    s_add_u32 s63, s54, 376832
    buffer_load_dwordx4 v6, s[20:23], s63 offen lds
    s_add_u32 m0, s26, 20480
    s_add_u32 s63, s54, 425984
    buffer_load_dwordx4 v6, s[20:23], s63 offen lds
    s_add_u32 m0, s26, 94208
    s_add_u32 s63, s54, 475136
    buffer_load_dwordx4 v6, s[20:23], s63 offen lds
    s_add_u32 m0, s26, 98304
    s_add_u32 s63, s54, 524288
    buffer_load_dwordx4 v6, s[20:23], s63 offen lds
    s_add_u32 m0, s26, 24576
    s_add_u32 s63, s54, 573440
    buffer_load_dwordx4 v6, s[20:23], s63 offen lds
    s_add_u32 m0, s26, 28672
    s_add_u32 s63, s54, 622592
    buffer_load_dwordx4 v6, s[20:23], s63 offen lds
    s_add_u32 m0, s26, 32768
    s_add_u32 s63, s54, 671744
    buffer_load_dwordx4 v6, s[20:23], s63 offen lds
    s_waitcnt vmcnt(37)
    s_barrier
    ds_read_b64_tr_b16 v[16:17], v178 offset:40960
    ds_read_b64_tr_b16 v[18:19], v178 offset:41472
    ds_read_b64_tr_b16 v[20:21], v179 offset:40960
    ds_read_b64_tr_b16 v[22:23], v179 offset:41472
    ds_read_b64_tr_b16 v[24:25], v178 offset:45056
    ds_read_b64_tr_b16 v[26:27], v178 offset:45568
    ds_read_b64_tr_b16 v[28:29], v179 offset:45056
    ds_read_b64_tr_b16 v[30:31], v179 offset:45568
    ds_read_b64_tr_b16 v[32:33], v178 offset:49152
    ds_read_b64_tr_b16 v[34:35], v178 offset:49664
    ds_read_b64_tr_b16 v[36:37], v179 offset:49152
    ds_read_b64_tr_b16 v[38:39], v179 offset:49664
    s_waitcnt lgkmcnt(0)
    s_barrier
    s_add_u32 m0, s26, 102400
    s_add_u32 s63, s52, 507904
    buffer_load_dwordx4 v6, s[20:23], s63 offen lds
    s_add_u32 m0, s26, 106496
    s_add_u32 s63, s52, 557056
    buffer_load_dwordx4 v6, s[20:23], s63 offen lds
    s_add_u32 m0, s26, 110592
    s_add_u32 s63, s52, 606208
    buffer_load_dwordx4 v6, s[20:23], s63 offen lds
    s_branch F_g2
F_hra0:
    s_sub_u32 s18, s18, 1
    s_cbranch_scc1 F_hxa0
    s_add_u32 m0, s25, 36864
    s_add_u32 s63, s5, 0
    s_and_b32 s63, s63, 15
    s_lshl_b32 s63, s63, 10
    s_xor_b32 s63, s63, s28
    buffer_load_dwordx4 v14, s[44:47], s63 offen offset:0 sc1 lds
    buffer_load_dwordx4 v15, s[44:47], s63 offen offset:1024 sc1 lds
    s_waitcnt vmcnt(0)
    ds_read_b64 v[224:225], v3 offset:8
    ds_read_b64 v[226:227], v3 offset:1032
    s_waitcnt lgkmcnt(0)
    v_cmp_eq_u64 vcc, v[224:225], v[220:221]
    v_cmp_eq_u64 s[14:15], v[226:227], v[220:221]
    s_nop 0
    s_or_b64 vcc, vcc, s[14:15]
    s_cbranch_scc1 F_hra0
    s_branch F_hba0
F_hxa0:
    s_mov_b32 s18, 0
    s_branch F_hba0
F_hra1:
    s_sub_u32 s18, s18, 1
    s_cbranch_scc1 F_hxa1
    s_add_u32 m0, s25, 44544
    s_add_u32 s63, s5, 0
    s_and_b32 s63, s63, 15
    s_lshl_b32 s63, s63, 10
    s_xor_b32 s63, s63, s28
    buffer_load_dwordx4 v14, s[44:47], s63 offen offset:512 sc1 lds
    buffer_load_dwordx4 v15, s[44:47], s63 offen offset:1536 sc1 lds
    s_waitcnt vmcnt(0)
    ds_read_b64 v[228:229], v3 offset:8200
    ds_read_b64 v[230:231], v3 offset:9224
    s_waitcnt lgkmcnt(0)
    v_cmp_eq_u64 vcc, v[228:229], v[220:221]
    v_cmp_eq_u64 s[14:15], v[230:231], v[220:221]
    s_nop 0
    s_or_b64 vcc, vcc, s[14:15]
    s_cbranch_scc1 F_hra1
    s_branch F_hba1
F_hxa1:
    s_mov_b32 s18, 0
    s_branch F_hba1
F_hra2:
    s_sub_u32 s18, s18, 1
    s_cbranch_scc1 F_hxa2
    s_add_u32 m0, s25, 53248
    s_add_u32 s63, s5, 2
    s_and_b32 s63, s63, 15
    s_lshl_b32 s63, s63, 10
    s_xor_b32 s63, s63, s28
    buffer_load_dwordx4 v14, s[44:47], s63 offen offset:0 sc1 lds
    buffer_load_dwordx4 v15, s[44:47], s63 offen offset:1024 sc1 lds
    s_waitcnt vmcnt(0)
    ds_read_b64 v[232:233], v3 offset:16392
    ds_read_b64 v[234:235], v3 offset:17416
    s_waitcnt lgkmcnt(0)
    v_cmp_eq_u64 vcc, v[232:233], v[220:221]
    v_cmp_eq_u64 s[14:15], v[234:235], v[220:221]
    s_nop 0
    s_or_b64 vcc, vcc, s[14:15]
    s_cbranch_scc1 F_hra2
    s_branch F_hba2
F_hxa2:
    s_mov_b32 s18, 0
    s_branch F_hba2
F_hra3:
    s_sub_u32 s18, s18, 1
    s_cbranch_scc1 F_hxa3
    s_add_u32 m0, s25, 60928
    s_add_u32 s63, s5, 2
    s_and_b32 s63, s63, 15
    s_lshl_b32 s63, s63, 10
    s_xor_b32 s63, s63, s28
    buffer_load_dwordx4 v14, s[44:47], s63 offen offset:512 sc1 lds
    buffer_load_dwordx4 v15, s[44:47], s63 offen offset:1536 sc1 lds
    s_waitcnt vmcnt(0)
    ds_read_b64 v[236:237], v3 offset:24584
    ds_read_b64 v[238:239], v3 offset:25608
    s_waitcnt lgkmcnt(0)
    v_cmp_eq_u64 vcc, v[236:237], v[220:221]
    v_cmp_eq_u64 s[14:15], v[238:239], v[220:221]
    s_nop 0
    s_or_b64 vcc, vcc, s[14:15]
    s_cbranch_scc1 F_hra3
    s_branch F_hba3
F_hxa3:
    s_mov_b32 s18, 0
    s_branch F_hba3
F_hra4:
    s_sub_u32 s18, s18, 1
    s_cbranch_scc1 F_hxa4
    s_add_u32 m0, s25, 69632
    s_add_u32 s63, s5, 4
    s_and_b32 s63, s63, 15
    s_lshl_b32 s63, s63, 10
    s_xor_b32 s63, s63, s28
    buffer_load_dwordx4 v14, s[44:47], s63 offen offset:0 sc1 lds
    buffer_load_dwordx4 v15, s[44:47], s63 offen offset:1024 sc1 lds
    s_waitcnt vmcnt(0)
    ds_read_b64 v[224:225], v3 offset:32776
    ds_read_b64 v[226:227], v3 offset:33800
    s_waitcnt lgkmcnt(0)
    v_cmp_eq_u64 vcc, v[224:225], v[220:221]
    v_cmp_eq_u64 s[14:15], v[226:227], v[220:221]
    s_nop 0
    s_or_b64 vcc, vcc, s[14:15]
    s_cbranch_scc1 F_hra4
    s_branch F_hba4
F_hxa4:
    s_mov_b32 s18, 0
    s_branch F_hba4
F_hra5:
    s_sub_u32 s18, s18, 1
    s_cbranch_scc1 F_hxa5
    s_add_u32 m0, s25, 77312
    s_add_u32 s63, s5, 4
    s_and_b32 s63, s63, 15
    s_lshl_b32 s63, s63, 10
    s_xor_b32 s63, s63, s28
    buffer_load_dwordx4 v14, s[44:47], s63 offen offset:512 sc1 lds
    buffer_load_dwordx4 v15, s[44:47], s63 offen offset:1536 sc1 lds
    s_waitcnt vmcnt(0)
    ds_read_b64 v[228:229], v3 offset:40968
    ds_read_b64 v[230:231], v3 offset:41992
    s_waitcnt lgkmcnt(0)
    v_cmp_eq_u64 vcc, v[228:229], v[220:221]
    v_cmp_eq_u64 s[14:15], v[230:231], v[220:221]
    s_nop 0
    s_or_b64 vcc, vcc, s[14:15]
    s_cbranch_scc1 F_hra5
    s_branch F_hba5
F_hxa5:
    s_mov_b32 s18, 0
    s_branch F_hba5
F_hra6:
    s_sub_u32 s18, s18, 1
    s_cbranch_scc1 F_hxa6
    s_add_u32 m0, s25, 86016
    s_add_u32 s63, s5, 6
    s_and_b32 s63, s63, 15
    s_lshl_b32 s63, s63, 10
    s_xor_b32 s63, s63, s28
    buffer_load_dwordx4 v14, s[44:47], s63 offen offset:0 sc1 lds
    buffer_load_dwordx4 v15, s[44:47], s63 offen offset:1024 sc1 lds
    s_waitcnt vmcnt(0)
    ds_read_b64 v[232:233], v3 offset:49160
    ds_read_b64 v[234:235], v3 offset:50184
    s_waitcnt lgkmcnt(0)
    v_cmp_eq_u64 vcc, v[232:233], v[220:221]
    v_cmp_eq_u64 s[14:15], v[234:235], v[220:221]
    s_nop 0
    s_or_b64 vcc, vcc, s[14:15]
    s_cbranch_scc1 F_hra6
    s_branch F_hba6
F_hxa6:
    s_mov_b32 s18, 0
    s_branch F_hba6
F_hra7:
    s_sub_u32 s18, s18, 1
    s_cbranch_scc1 F_hxa7
    s_add_u32 m0, s25, 93696
    s_add_u32 s63, s5, 6
    s_and_b32 s63, s63, 15
    s_lshl_b32 s63, s63, 10
    s_xor_b32 s63, s63, s28
    buffer_load_dwordx4 v14, s[44:47], s63 offen offset:512 sc1 lds
    buffer_load_dwordx4 v15, s[44:47], s63 offen offset:1536 sc1 lds
    s_waitcnt vmcnt(0)
    ds_read_b64 v[236:237], v3 offset:57352
    ds_read_b64 v[238:239], v3 offset:58376
    s_waitcnt lgkmcnt(0)
    v_cmp_eq_u64 vcc, v[236:237], v[220:221]
    v_cmp_eq_u64 s[14:15], v[238:239], v[220:221]
    s_nop 0
    s_or_b64 vcc, vcc, s[14:15]
    s_cbranch_scc1 F_hra7
    s_branch F_hba7
F_hxa7:
    s_mov_b32 s18, 0
    s_branch F_hba7
F_hra8:
    s_sub_u32 s18, s18, 1
    s_cbranch_scc1 F_hxa8
    s_add_u32 m0, s25, 36864
    s_add_u32 s63, s5, 8
    s_and_b32 s63, s63, 15
    s_lshl_b32 s63, s63, 10
    s_xor_b32 s63, s63, s28
    buffer_load_dwordx4 v14, s[44:47], s63 offen offset:0 sc1 lds
    buffer_load_dwordx4 v15, s[44:47], s63 offen offset:1024 sc1 lds
    s_waitcnt vmcnt(0)
    ds_read_b64 v[224:225], v3 offset:8
    ds_read_b64 v[226:227], v3 offset:1032
    s_waitcnt lgkmcnt(0)
    v_cmp_eq_u64 vcc, v[224:225], v[220:221]
    v_cmp_eq_u64 s[14:15], v[226:227], v[220:221]
    s_nop 0
    s_or_b64 vcc, vcc, s[14:15]
    s_cbranch_scc1 F_hra8
    s_branch F_hba8
F_hxa8:
    s_mov_b32 s18, 0
    s_branch F_hba8
F_hra9:
    s_sub_u32 s18, s18, 1
    s_cbranch_scc1 F_hxa9
    s_add_u32 m0, s25, 44544
    s_add_u32 s63, s5, 8
    s_and_b32 s63, s63, 15
    s_lshl_b32 s63, s63, 10
    s_xor_b32 s63, s63, s28
    buffer_load_dwordx4 v14, s[44:47], s63 offen offset:512 sc1 lds
    buffer_load_dwordx4 v15, s[44:47], s63 offen offset:1536 sc1 lds
    s_waitcnt vmcnt(0)
    ds_read_b64 v[228:229], v3 offset:8200
    ds_read_b64 v[230:231], v3 offset:9224
    s_waitcnt lgkmcnt(0)
    v_cmp_eq_u64 vcc, v[228:229], v[220:221]
    v_cmp_eq_u64 s[14:15], v[230:231], v[220:221]
    s_nop 0
    s_or_b64 vcc, vcc, s[14:15]
    s_cbranch_scc1 F_hra9
    s_branch F_hba9
F_hxa9:
    s_mov_b32 s18, 0
    s_branch F_hba9
F_hra10:
    s_sub_u32 s18, s18, 1
    s_cbranch_scc1 F_hxa10
    s_add_u32 m0, s25, 53248
    s_add_u32 s63, s5, 10
    s_and_b32 s63, s63, 15
    s_lshl_b32 s63, s63, 10
    s_xor_b32 s63, s63, s28
    buffer_load_dwordx4 v14, s[44:47], s63 offen offset:0 sc1 lds
    buffer_load_dwordx4 v15, s[44:47], s63 offen offset:1024 sc1 lds
    s_waitcnt vmcnt(0)
    ds_read_b64 v[232:233], v3 offset:16392
    ds_read_b64 v[234:235], v3 offset:17416
    s_waitcnt lgkmcnt(0)
    v_cmp_eq_u64 vcc, v[232:233], v[220:221]
    v_cmp_eq_u64 s[14:15], v[234:235], v[220:221]
    s_nop 0
    s_or_b64 vcc, vcc, s[14:15]
    s_cbranch_scc1 F_hra10
    s_branch F_hba10
F_hxa10:
    s_mov_b32 s18, 0
    s_branch F_hba10
F_hra11:
    s_sub_u32 s18, s18, 1
    s_cbranch_scc1 F_hxa11
    s_add_u32 m0, s25, 60928
    s_add_u32 s63, s5, 10
    s_and_b32 s63, s63, 15
    s_lshl_b32 s63, s63, 10
    s_xor_b32 s63, s63, s28
    buffer_load_dwordx4 v14, s[44:47], s63 offen offset:512 sc1 lds
    buffer_load_dwordx4 v15, s[44:47], s63 offen offset:1536 sc1 lds
    s_waitcnt vmcnt(0)
    ds_read_b64 v[236:237], v3 offset:24584
    ds_read_b64 v[238:239], v3 offset:25608
    s_waitcnt lgkmcnt(0)
    v_cmp_eq_u64 vcc, v[236:237], v[220:221]
    v_cmp_eq_u64 s[14:15], v[238:239], v[220:221]
    s_nop 0
    s_or_b64 vcc, vcc, s[14:15]
    s_cbranch_scc1 F_hra11
    s_branch F_hba11
F_hxa11:
    s_mov_b32 s18, 0
    s_branch F_hba11
F_hra12:
    s_sub_u32 s18, s18, 1
    s_cbranch_scc1 F_hxa12
    s_add_u32 m0, s25, 69632
    s_add_u32 s63, s5, 12
    s_and_b32 s63, s63, 15
    s_lshl_b32 s63, s63, 10
    s_xor_b32 s63, s63, s28
    buffer_load_dwordx4 v14, s[44:47], s63 offen offset:0 sc1 lds
    buffer_load_dwordx4 v15, s[44:47], s63 offen offset:1024 sc1 lds
    s_waitcnt vmcnt(0)
    ds_read_b64 v[224:225], v3 offset:32776
    ds_read_b64 v[226:227], v3 offset:33800
    s_waitcnt lgkmcnt(0)
    v_cmp_eq_u64 vcc, v[224:225], v[220:221]
    v_cmp_eq_u64 s[14:15], v[226:227], v[220:221]
    s_nop 0
    s_or_b64 vcc, vcc, s[14:15]
    s_cbranch_scc1 F_hra12
    s_branch F_hba12
F_hxa12:
    s_mov_b32 s18, 0
    s_branch F_hba12
F_hra13:
    s_sub_u32 s18, s18, 1
    s_cbranch_scc1 F_hxa13
    s_add_u32 m0, s25, 77312
    s_add_u32 s63, s5, 12
    s_and_b32 s63, s63, 15
    s_lshl_b32 s63, s63, 10
    s_xor_b32 s63, s63, s28
    buffer_load_dwordx4 v14, s[44:47], s63 offen offset:512 sc1 lds
    buffer_load_dwordx4 v15, s[44:47], s63 offen offset:1536 sc1 lds
    s_waitcnt vmcnt(0)
    ds_read_b64 v[228:229], v3 offset:40968
    ds_read_b64 v[230:231], v3 offset:41992
    s_waitcnt lgkmcnt(0)
    v_cmp_eq_u64 vcc, v[228:229], v[220:221]
    v_cmp_eq_u64 s[14:15], v[230:231], v[220:221]
    s_nop 0
    s_or_b64 vcc, vcc, s[14:15]
    s_cbranch_scc1 F_hra13
    s_branch F_hba13
F_hxa13:
    s_mov_b32 s18, 0
    s_branch F_hba13
F_hra14:
    s_sub_u32 s18, s18, 1
    s_cbranch_scc1 F_hxa14
    s_add_u32 m0, s25, 86016
    s_add_u32 s63, s5, 14
    s_and_b32 s63, s63, 15
    s_lshl_b32 s63, s63, 10
    s_xor_b32 s63, s63, s28
    buffer_load_dwordx4 v14, s[44:47], s63 offen offset:0 sc1 lds
    buffer_load_dwordx4 v15, s[44:47], s63 offen offset:1024 sc1 lds
    s_waitcnt vmcnt(0)
    ds_read_b64 v[232:233], v3 offset:49160
    ds_read_b64 v[234:235], v3 offset:50184
    s_waitcnt lgkmcnt(0)
    v_cmp_eq_u64 vcc, v[232:233], v[220:221]
    v_cmp_eq_u64 s[14:15], v[234:235], v[220:221]
    s_nop 0
    s_or_b64 vcc, vcc, s[14:15]
    s_cbranch_scc1 F_hra14
    s_branch F_hba14
F_hxa14:
    s_mov_b32 s18, 0
    s_branch F_hba14
F_hra15:
    s_sub_u32 s18, s18, 1
    s_cbranch_scc1 F_hxa15
    s_add_u32 m0, s25, 93696
    s_add_u32 s63, s5, 14
    s_and_b32 s63, s63, 15
    s_lshl_b32 s63, s63, 10
    s_xor_b32 s63, s63, s28
    buffer_load_dwordx4 v14, s[44:47], s63 offen offset:512 sc1 lds
    buffer_load_dwordx4 v15, s[44:47], s63 offen offset:1536 sc1 lds
    s_waitcnt vmcnt(0)
    ds_read_b64 v[236:237], v3 offset:57352
    ds_read_b64 v[238:239], v3 offset:58376
    s_waitcnt lgkmcnt(0)
    v_cmp_eq_u64 vcc, v[236:237], v[220:221]
    v_cmp_eq_u64 s[14:15], v[238:239], v[220:221]
    s_nop 0
    s_or_b64 vcc, vcc, s[14:15]
    s_cbranch_scc1 F_hra15
    s_branch F_hba15
F_hxa15:
    s_mov_b32 s18, 0
    s_branch F_hba15
F_gr0:
    v_cmp_eq_u64 vcc, -1, v[98:99]
    s_cbranch_vccz F_gb0
    s_sub_u32 s18, s18, 1
    s_cbranch_scc1 F_gx0
    s_add_u32 s63, s55, 0
    buffer_load_dwordx4 v[96:99], v2, s[36:39], s63 offen offset:0 sc1
    s_waitcnt vmcnt(0)
    s_branch F_gr0
F_gx0:
    s_mov_b32 s18, 0
    s_branch F_gb0
F_gr1:
    v_cmp_eq_u64 vcc, -1, v[102:103]
    s_cbranch_vccz F_gb1
    s_sub_u32 s18, s18, 1
    s_cbranch_scc1 F_gx1
    s_add_u32 s63, s55, 0
    buffer_load_dwordx4 v[100:103], v2, s[36:39], s63 offen offset:1024 sc1
    s_waitcnt vmcnt(0)
    s_branch F_gr1
F_gx1:
    s_mov_b32 s18, 0
    s_branch F_gb1
F_gr2:
    v_cmp_eq_u64 vcc, -1, v[106:107]
    s_cbranch_vccz F_gb2
    s_sub_u32 s18, s18, 1
    s_cbranch_scc1 F_gx2
    s_add_u32 s63, s55, 0
    buffer_load_dwordx4 v[104:107], v2, s[36:39], s63 offen offset:2048 sc1
    s_waitcnt vmcnt(0)
    s_branch F_gr2
F_gx2:
    s_mov_b32 s18, 0
    s_branch F_gb2
F_gr3:
    v_cmp_eq_u64 vcc, -1, v[110:111]
    s_cbranch_vccz F_gb3
    s_sub_u32 s18, s18, 1
    s_cbranch_scc1 F_gx3
    s_add_u32 s63, s55, 0
    buffer_load_dwordx4 v[108:111], v2, s[36:39], s63 offen offset:3072 sc1
    s_waitcnt vmcnt(0)
    s_branch F_gr3
F_gx3:
    s_mov_b32 s18, 0
    s_branch F_gb3
F_gr4:
    v_cmp_eq_u64 vcc, -1, v[114:115]
    s_cbranch_vccz F_gb4
    s_sub_u32 s18, s18, 1
    s_cbranch_scc1 F_gx4
    s_add_u32 s63, s55, 4096
    buffer_load_dwordx4 v[112:115], v2, s[36:39], s63 offen offset:0 sc1
    s_waitcnt vmcnt(0)
    s_branch F_gr4
F_gx4:
    s_mov_b32 s18, 0
    s_branch F_gb4
F_gr5:
    v_cmp_eq_u64 vcc, -1, v[118:119]
    s_cbranch_vccz F_gb5
    s_sub_u32 s18, s18, 1
    s_cbranch_scc1 F_gx5
    s_add_u32 s63, s55, 4096
    buffer_load_dwordx4 v[116:119], v2, s[36:39], s63 offen offset:1024 sc1
    s_waitcnt vmcnt(0)
    s_branch F_gr5
F_gx5:
    s_mov_b32 s18, 0
    s_branch F_gb5
F_gr6:
    v_cmp_eq_u64 vcc, -1, v[122:123]
    s_cbranch_vccz F_gb6
    s_sub_u32 s18, s18, 1
    s_cbranch_scc1 F_gx6
    s_add_u32 s63, s55, 4096
    buffer_load_dwordx4 v[120:123], v2, s[36:39], s63 offen offset:2048 sc1
    s_waitcnt vmcnt(0)
    s_branch F_gr6
F_gx6:
    s_mov_b32 s18, 0
    s_branch F_gb6
F_gr7:
    v_cmp_eq_u64 vcc, -1, v[126:127]
    s_cbranch_vccz F_gb7
    s_sub_u32 s18, s18, 1
    s_cbranch_scc1 F_gx7
    s_add_u32 s63, s55, 4096
    buffer_load_dwordx4 v[124:127], v2, s[36:39], s63 offen offset:3072 sc1
    s_waitcnt vmcnt(0)
    s_branch F_gr7
F_gx7:
    s_mov_b32 s18, 0
    s_branch F_gb7
F_gr8:
    v_cmp_eq_u64 vcc, -1, v[130:131]
    s_cbranch_vccz F_gb8
    s_sub_u32 s18, s18, 1
    s_cbranch_scc1 F_gx8
    s_add_u32 s63, s55, 8192
    buffer_load_dwordx4 v[128:131], v2, s[36:39], s63 offen offset:0 sc1
    s_waitcnt vmcnt(0)
    s_branch F_gr8
F_gx8:
    s_mov_b32 s18, 0
    s_branch F_gb8
F_gr9:
    v_cmp_eq_u64 vcc, -1, v[134:135]
    s_cbranch_vccz F_gb9
    s_sub_u32 s18, s18, 1
    s_cbranch_scc1 F_gx9
    s_add_u32 s63, s55, 8192
    buffer_load_dwordx4 v[132:135], v2, s[36:39], s63 offen offset:1024 sc1
    s_waitcnt vmcnt(0)
    s_branch F_gr9
F_gx9:
    s_mov_b32 s18, 0
    s_branch F_gb9
F_gr10:
    v_cmp_eq_u64 vcc, -1, v[138:139]
    s_cbranch_vccz F_gb10
    s_sub_u32 s18, s18, 1
    s_cbranch_scc1 F_gx10
    s_add_u32 s63, s55, 8192
    buffer_load_dwordx4 v[136:139], v2, s[36:39], s63 offen offset:2048 sc1
    s_waitcnt vmcnt(0)
    s_branch F_gr10
F_gx10:
    s_mov_b32 s18, 0
    s_branch F_gb10
F_gr11:
    v_cmp_eq_u64 vcc, -1, v[142:143]
    s_cbranch_vccz F_gb11
    s_sub_u32 s18, s18, 1
    s_cbranch_scc1 F_gx11
    s_add_u32 s63, s55, 8192
    buffer_load_dwordx4 v[140:143], v2, s[36:39], s63 offen offset:3072 sc1
    s_waitcnt vmcnt(0)
    s_branch F_gr11
F_gx11:
    s_mov_b32 s18, 0
    s_branch F_gb11
F_gr12:
    v_cmp_eq_u64 vcc, -1, v[146:147]
    s_cbranch_vccz F_gb12
    s_sub_u32 s18, s18, 1
    s_cbranch_scc1 F_gx12
    s_add_u32 s63, s55, 12288
    buffer_load_dwordx4 v[144:147], v2, s[36:39], s63 offen offset:0 sc1
    s_waitcnt vmcnt(0)
    s_branch F_gr12
F_gx12:
    s_mov_b32 s18, 0
    s_branch F_gb12
F_gr13:
    v_cmp_eq_u64 vcc, -1, v[150:151]
    s_cbranch_vccz F_gb13
    s_sub_u32 s18, s18, 1
    s_cbranch_scc1 F_gx13
    s_add_u32 s63, s55, 12288
    buffer_load_dwordx4 v[148:151], v2, s[36:39], s63 offen offset:1024 sc1
    s_waitcnt vmcnt(0)
    s_branch F_gr13
F_gx13:
    s_mov_b32 s18, 0
    s_branch F_gb13
F_gr14:
    v_cmp_eq_u64 vcc, -1, v[154:155]
    s_cbranch_vccz F_gb14
    s_sub_u32 s18, s18, 1
    s_cbranch_scc1 F_gx14
    s_add_u32 s63, s55, 12288
    buffer_load_dwordx4 v[152:155], v2, s[36:39], s63 offen offset:2048 sc1
    s_waitcnt vmcnt(0)
    s_branch F_gr14
F_gx14:
    s_mov_b32 s18, 0
    s_branch F_gb14
F_gr15:
    v_cmp_eq_u64 vcc, -1, v[158:159]
    s_cbranch_vccz F_gb15
    s_sub_u32 s18, s18, 1
    s_cbranch_scc1 F_gx15
    s_add_u32 s63, s55, 12288
    buffer_load_dwordx4 v[156:159], v2, s[36:39], s63 offen offset:3072 sc1
    s_waitcnt vmcnt(0)
    s_branch F_gr15
F_gx15:
    s_mov_b32 s18, 0
    s_branch F_gb15
F_gr16:
    v_cmp_eq_u64 vcc, -1, v[98:99]
    s_cbranch_vccz F_gb16
    s_sub_u32 s18, s18, 1
    s_cbranch_scc1 F_gx16
    s_add_u32 s63, s55, 16384
    buffer_load_dwordx4 v[96:99], v2, s[36:39], s63 offen offset:0 sc1
    s_waitcnt vmcnt(0)
    s_branch F_gr16
F_gx16:
    s_mov_b32 s18, 0
    s_branch F_gb16
F_gr17:
    v_cmp_eq_u64 vcc, -1, v[102:103]
    s_cbranch_vccz F_gb17
    s_sub_u32 s18, s18, 1
    s_cbranch_scc1 F_gx17
    s_add_u32 s63, s55, 16384
    buffer_load_dwordx4 v[100:103], v2, s[36:39], s63 offen offset:1024 sc1
    s_waitcnt vmcnt(0)
    s_branch F_gr17
F_gx17:
    s_mov_b32 s18, 0
    s_branch F_gb17
F_gr18:
    v_cmp_eq_u64 vcc, -1, v[106:107]
    s_cbranch_vccz F_gb18
    s_sub_u32 s18, s18, 1
    s_cbranch_scc1 F_gx18
    s_add_u32 s63, s55, 16384
    buffer_load_dwordx4 v[104:107], v2, s[36:39], s63 offen offset:2048 sc1
    s_waitcnt vmcnt(0)
    s_branch F_gr18
F_gx18:
    s_mov_b32 s18, 0
    s_branch F_gb18
F_gr19:
    v_cmp_eq_u64 vcc, -1, v[110:111]
    s_cbranch_vccz F_gb19
    s_sub_u32 s18, s18, 1
    s_cbranch_scc1 F_gx19
    s_add_u32 s63, s55, 16384
    buffer_load_dwordx4 v[108:111], v2, s[36:39], s63 offen offset:3072 sc1
    s_waitcnt vmcnt(0)
    s_branch F_gr19
F_gx19:
    s_mov_b32 s18, 0
    s_branch F_gb19
F_gr20:
    v_cmp_eq_u64 vcc, -1, v[114:115]
    s_cbranch_vccz F_gb20
    s_sub_u32 s18, s18, 1
    s_cbranch_scc1 F_gx20
    s_add_u32 s63, s55, 20480
    buffer_load_dwordx4 v[112:115], v2, s[36:39], s63 offen offset:0 sc1
    s_waitcnt vmcnt(0)
    s_branch F_gr20
F_gx20:
    s_mov_b32 s18, 0
    s_branch F_gb20
F_gr21:
    v_cmp_eq_u64 vcc, -1, v[118:119]
    s_cbranch_vccz F_gb21
    s_sub_u32 s18, s18, 1
    s_cbranch_scc1 F_gx21
    s_add_u32 s63, s55, 20480
    buffer_load_dwordx4 v[116:119], v2, s[36:39], s63 offen offset:1024 sc1
    s_waitcnt vmcnt(0)
    s_branch F_gr21
F_gx21:
    s_mov_b32 s18, 0
    s_branch F_gb21
F_gr22:
    v_cmp_eq_u64 vcc, -1, v[122:123]
    s_cbranch_vccz F_gb22
    s_sub_u32 s18, s18, 1
    s_cbranch_scc1 F_gx22
    s_add_u32 s63, s55, 20480
    buffer_load_dwordx4 v[120:123], v2, s[36:39], s63 offen offset:2048 sc1
    s_waitcnt vmcnt(0)
    s_branch F_gr22
F_gx22:
    s_mov_b32 s18, 0
    s_branch F_gb22
F_gr23:
    v_cmp_eq_u64 vcc, -1, v[126:127]
    s_cbranch_vccz F_gb23
    s_sub_u32 s18, s18, 1
    s_cbranch_scc1 F_gx23
    s_add_u32 s63, s55, 20480
    buffer_load_dwordx4 v[124:127], v2, s[36:39], s63 offen offset:3072 sc1
    s_waitcnt vmcnt(0)
    s_branch F_gr23
F_gx23:
    s_mov_b32 s18, 0
    s_branch F_gb23
F_gr24:
    v_cmp_eq_u64 vcc, -1, v[130:131]
    s_cbranch_vccz F_gb24
    s_sub_u32 s18, s18, 1
    s_cbranch_scc1 F_gx24
    s_add_u32 s63, s55, 24576
    buffer_load_dwordx4 v[128:131], v2, s[36:39], s63 offen offset:0 sc1
    s_waitcnt vmcnt(0)
    s_branch F_gr24
F_gx24:
    s_mov_b32 s18, 0
    s_branch F_gb24
F_gr25:
    v_cmp_eq_u64 vcc, -1, v[134:135]
    s_cbranch_vccz F_gb25
    s_sub_u32 s18, s18, 1
    s_cbranch_scc1 F_gx25
    s_add_u32 s63, s55, 24576
    buffer_load_dwordx4 v[132:135], v2, s[36:39], s63 offen offset:1024 sc1
    s_waitcnt vmcnt(0)
    s_branch F_gr25
F_gx25:
    s_mov_b32 s18, 0
    s_branch F_gb25
F_gr26:
    v_cmp_eq_u64 vcc, -1, v[138:139]
    s_cbranch_vccz F_gb26
    s_sub_u32 s18, s18, 1
    s_cbranch_scc1 F_gx26
    s_add_u32 s63, s55, 24576
    buffer_load_dwordx4 v[136:139], v2, s[36:39], s63 offen offset:2048 sc1
    s_waitcnt vmcnt(0)
    s_branch F_gr26
F_gx26:
    s_mov_b32 s18, 0
    s_branch F_gb26
F_gr27:
    v_cmp_eq_u64 vcc, -1, v[142:143]
    s_cbranch_vccz F_gb27
    s_sub_u32 s18, s18, 1
    s_cbranch_scc1 F_gx27
    s_add_u32 s63, s55, 24576
    buffer_load_dwordx4 v[140:143], v2, s[36:39], s63 offen offset:3072 sc1
    s_waitcnt vmcnt(0)
    s_branch F_gr27
F_gx27:
    s_mov_b32 s18, 0
    s_branch F_gb27
F_gr28:
    v_cmp_eq_u64 vcc, -1, v[146:147]
    s_cbranch_vccz F_gb28
    s_sub_u32 s18, s18, 1
    s_cbranch_scc1 F_gx28
    s_add_u32 s63, s55, 28672
    buffer_load_dwordx4 v[144:147], v2, s[36:39], s63 offen offset:0 sc1
    s_waitcnt vmcnt(0)
    s_branch F_gr28
F_gx28:
    s_mov_b32 s18, 0
    s_branch F_gb28
F_gr29:
    v_cmp_eq_u64 vcc, -1, v[150:151]
    s_cbranch_vccz F_gb29
    s_sub_u32 s18, s18, 1
    s_cbranch_scc1 F_gx29
    s_add_u32 s63, s55, 28672
    buffer_load_dwordx4 v[148:151], v2, s[36:39], s63 offen offset:1024 sc1
    s_waitcnt vmcnt(0)
    s_branch F_gr29
F_gx29:
    s_mov_b32 s18, 0
    s_branch F_gb29
F_gr30:
    v_cmp_eq_u64 vcc, -1, v[154:155]
    s_cbranch_vccz F_gb30
    s_sub_u32 s18, s18, 1
    s_cbranch_scc1 F_gx30
    s_add_u32 s63, s55, 28672
    buffer_load_dwordx4 v[152:155], v2, s[36:39], s63 offen offset:2048 sc1
    s_waitcnt vmcnt(0)
    s_branch F_gr30
F_gx30:
    s_mov_b32 s18, 0
    s_branch F_gb30
F_gr31:
    v_cmp_eq_u64 vcc, -1, v[158:159]
    s_cbranch_vccz F_gb31
    s_sub_u32 s18, s18, 1
    s_cbranch_scc1 F_gx31
    s_add_u32 s63, s55, 28672
    buffer_load_dwordx4 v[156:159], v2, s[36:39], s63 offen offset:3072 sc1
    s_waitcnt vmcnt(0)
    s_branch F_gr31
F_gx31:
    s_mov_b32 s18, 0
    s_branch F_gb31
F_gr32:
    v_cmp_eq_u64 vcc, -1, v[98:99]
    s_cbranch_vccz F_gb32
    s_sub_u32 s18, s18, 1
    s_cbranch_scc1 F_gx32
    s_add_u32 s63, s55, 32768
    buffer_load_dwordx4 v[96:99], v2, s[36:39], s63 offen offset:0 sc1
    s_waitcnt vmcnt(0)
    s_branch F_gr32
F_gx32:
    s_mov_b32 s18, 0
    s_branch F_gb32
F_gr33:
    v_cmp_eq_u64 vcc, -1, v[102:103]
    s_cbranch_vccz F_gb33
    s_sub_u32 s18, s18, 1
    s_cbranch_scc1 F_gx33
    s_add_u32 s63, s55, 32768
    buffer_load_dwordx4 v[100:103], v2, s[36:39], s63 offen offset:1024 sc1
    s_waitcnt vmcnt(0)
    s_branch F_gr33
F_gx33:
    s_mov_b32 s18, 0
    s_branch F_gb33
F_gr34:
    v_cmp_eq_u64 vcc, -1, v[106:107]
    s_cbranch_vccz F_gb34
    s_sub_u32 s18, s18, 1
    s_cbranch_scc1 F_gx34
    s_add_u32 s63, s55, 32768
    buffer_load_dwordx4 v[104:107], v2, s[36:39], s63 offen offset:2048 sc1
    s_waitcnt vmcnt(0)
    s_branch F_gr34
F_gx34:
    s_mov_b32 s18, 0
    s_branch F_gb34
F_gr35:
    v_cmp_eq_u64 vcc, -1, v[110:111]
    s_cbranch_vccz F_gb35
    s_sub_u32 s18, s18, 1
    s_cbranch_scc1 F_gx35
    s_add_u32 s63, s55, 32768
    buffer_load_dwordx4 v[108:111], v2, s[36:39], s63 offen offset:3072 sc1
    s_waitcnt vmcnt(0)
    s_branch F_gr35
F_gx35:
    s_mov_b32 s18, 0
    s_branch F_gb35
F_gr36:
    v_cmp_eq_u64 vcc, -1, v[114:115]
    s_cbranch_vccz F_gb36
    s_sub_u32 s18, s18, 1
    s_cbranch_scc1 F_gx36
    s_add_u32 s63, s55, 36864
    buffer_load_dwordx4 v[112:115], v2, s[36:39], s63 offen offset:0 sc1
    s_waitcnt vmcnt(0)
    s_branch F_gr36
F_gx36:
    s_mov_b32 s18, 0
    s_branch F_gb36
F_gr37:
    v_cmp_eq_u64 vcc, -1, v[118:119]
    s_cbranch_vccz F_gb37
    s_sub_u32 s18, s18, 1
    s_cbranch_scc1 F_gx37
    s_add_u32 s63, s55, 36864
    buffer_load_dwordx4 v[116:119], v2, s[36:39], s63 offen offset:1024 sc1
    s_waitcnt vmcnt(0)
    s_branch F_gr37
F_gx37:
    s_mov_b32 s18, 0
    s_branch F_gb37
F_gr38:
    v_cmp_eq_u64 vcc, -1, v[122:123]
    s_cbranch_vccz F_gb38
    s_sub_u32 s18, s18, 1
    s_cbranch_scc1 F_gx38
    s_add_u32 s63, s55, 36864
    buffer_load_dwordx4 v[120:123], v2, s[36:39], s63 offen offset:2048 sc1
    s_waitcnt vmcnt(0)
    s_branch F_gr38
F_gx38:
    s_mov_b32 s18, 0
    s_branch F_gb38
F_gr39:
    v_cmp_eq_u64 vcc, -1, v[126:127]
    s_cbranch_vccz F_gb39
    s_sub_u32 s18, s18, 1
    s_cbranch_scc1 F_gx39
    s_add_u32 s63, s55, 36864
    buffer_load_dwordx4 v[124:127], v2, s[36:39], s63 offen offset:3072 sc1
    s_waitcnt vmcnt(0)
    s_branch F_gr39
F_gx39:
    s_mov_b32 s18, 0
    s_branch F_gb39
F_gr40:
    v_cmp_eq_u64 vcc, -1, v[130:131]
    s_cbranch_vccz F_gb40
    s_sub_u32 s18, s18, 1
    s_cbranch_scc1 F_gx40
    s_add_u32 s63, s55, 40960
    buffer_load_dwordx4 v[128:131], v2, s[36:39], s63 offen offset:0 sc1
    s_waitcnt vmcnt(0)
    s_branch F_gr40
F_gx40:
    s_mov_b32 s18, 0
    s_branch F_gb40
F_gr41:
    v_cmp_eq_u64 vcc, -1, v[134:135]
    s_cbranch_vccz F_gb41
    s_sub_u32 s18, s18, 1
    s_cbranch_scc1 F_gx41
    s_add_u32 s63, s55, 40960
    buffer_load_dwordx4 v[132:135], v2, s[36:39], s63 offen offset:1024 sc1
    s_waitcnt vmcnt(0)
    s_branch F_gr41
F_gx41:
    s_mov_b32 s18, 0
    s_branch F_gb41
F_gr42:
    v_cmp_eq_u64 vcc, -1, v[138:139]
    s_cbranch_vccz F_gb42
    s_sub_u32 s18, s18, 1
    s_cbranch_scc1 F_gx42
    s_add_u32 s63, s55, 40960
    buffer_load_dwordx4 v[136:139], v2, s[36:39], s63 offen offset:2048 sc1
    s_waitcnt vmcnt(0)
    s_branch F_gr42
F_gx42:
    s_mov_b32 s18, 0
    s_branch F_gb42
B_end:
B_exit:
    s_endpgm
.section .rodata,"a"
.p2align 6
.amdhsa_kernel sequential_preLN__ssm_conv_s4d__glu_gated_glu__prompt_kernel
  .amdhsa_next_free_vgpr 256
  .amdhsa_next_free_sgpr 80
  .amdhsa_accum_offset 256
  .amdhsa_group_segment_fixed_size 0
  .amdhsa_kernarg_size 112
  .amdhsa_user_sgpr_count 2
  .amdhsa_user_sgpr_kernarg_segment_ptr 1
  .amdhsa_system_sgpr_workgroup_id_x 1
.end_amdhsa_kernel
.text
code_end:
```
